```python
import torch

def _softmax(x, axis=-1):
    return torch.softmax(x, dim=axis)
def _gelu(x):
    return torch.nn.functional.gelu(x, approximate="tanh")
def _silu(x):
    return torch.nn.functional.silu(x)
def _sigmoid(x):
    return torch.sigmoid(x)
def _layernorm(x, axis=-1, eps=1e-5):
    m = x.mean(dim=axis, keepdim=True)
    v = x.var(dim=axis, keepdim=True, unbiased=False)
    return (x - m) / torch.sqrt(v + eps)
def _scatter_add(tgt, idx, src, axis=0):
    return tgt.clone().index_add_(axis, idx, src)
def _segment_sum(src, seg, n):
    out = torch.zeros((n,) + src.shape[1:], dtype=src.dtype)
    return out.index_add_(0, seg, src)
def _pad(x, pw):
    flat = tuple(v for pair in reversed(pw) for v in pair)
    return torch.nn.functional.pad(x, flat)

kernel_name = 'parallel_sum__ssm_conv_s4d__glu_gated_glu__prompt'

def setup_inputs():

    _w = (lambda a: (lambda t: t.to(torch.bfloat16) if t.is_floating_point() else t)(torch.as_tensor(a)))
    def _A_setup():
        Bsz, L, D, N = 1, 2048, 512, 128
        return {
            "u": _w((lambda *s: torch.randn(*s, dtype=torch.bfloat16) * 0.05)(Bsz, L, D)),
            "log_A_real": _w((lambda *s: torch.randn(*s, dtype=torch.bfloat16) * 3.2)(D, N) * 0.5),
            "A_imag": _w((lambda *s: torch.randn(*s, dtype=torch.bfloat16) * 0.1)(D, N) * 3.14),
            "C_real": _w((lambda *s: torch.randn(*s, dtype=torch.bfloat16) * 0.8)(D, N) / N ** 0.5),
            "C_imag": _w((lambda *s: torch.randn(*s, dtype=torch.bfloat16) * 0.8)(D, N) / N ** 0.5),
            "log_dt": _w((lambda *s: torch.randn(*s, dtype=torch.bfloat16) * 0.1)(D) * 0.5 - 4.0),
            "D_skip": _w((lambda *s: torch.randn(*s, dtype=torch.bfloat16) * 0.1)(D)),
        }
    _A_in = _A_setup()

    def _B_setup():
        B, S, D, F = 1, 2048, 512, 1376
        return {
            "x": _w((lambda *s: torch.randn(*s, dtype=torch.bfloat16) * 0.05)(B, S, D)),
            "w_gate": _w((lambda *s: torch.randn(*s, dtype=torch.bfloat16) * 0.05)(D, F)),
            "w_up": _w((lambda *s: torch.randn(*s, dtype=torch.bfloat16) * 0.05)(D, F)),
            "w_down": _w((lambda *s: torch.randn(*s, dtype=torch.bfloat16) * 0.05)(F, D)),
        }
    _B_in = _B_setup()

    return {
        "A_u": _A_in["u"],
        "A_log_A_real": _A_in["log_A_real"],
        "A_A_imag": _A_in["A_imag"],
        "A_C_real": _A_in["C_real"],
        "A_C_imag": _A_in["C_imag"],
        "A_log_dt": _A_in["log_dt"],
        "A_D_skip": _A_in["D_skip"],
        "B_x": _B_in["x"],
        "B_w_gate": _B_in["w_gate"],
        "B_w_up": _B_in["w_up"],
        "B_w_down": _B_in["w_down"],
    }

def reference(A_u, A_log_A_real, A_A_imag, A_C_real, A_C_imag, A_log_dt, A_D_skip, B_x, B_w_gate, B_w_up, B_w_down):
    def _A_ref(u, log_A_real, A_imag, C_real, C_imag, log_dt, D_skip):
        L = u.shape[1]
        dt = torch.exp(log_dt)
        A = -torch.exp(log_A_real) + 1j * A_imag
        C = (C_real + 1j * C_imag) * dt[:, None]
        pos = (lambda x, dt: x.to(dt))(torch.arange(L), log_dt.dtype)
        P = torch.exp((A * dt[:, None])[:, :, None] * pos[None, None, :])
        K = 2.0 * torch.einsum("dn,dnl->dl", C, P).real
        L2 = 2 * L
        u_t = (lambda x, *d: x.permute(*d))(u, 0, 2, 1)
        Kf = (lambda x, *a, **k: torch.fft.rfft(x.float(), *a, **k))(K, L2)
        Uf = (lambda x, *a, **k: torch.fft.rfft(x.float(), *a, **k))(u_t, L2)
        y = (lambda x, *a, **k: torch.fft.irfft(x, *a, **k).to(torch.bfloat16))(Uf * Kf[None, :, :], L2)[:, :, :L]
        y = (lambda x, *d: x.permute(*d))(y, 0, 2, 1)
        return y + u * D_skip[None, None, :]

    def _B_ref(x, w_gate, w_up, w_down):
        g = torch.einsum("bsd,df->bsf", x, w_gate)
        u = torch.einsum("bsd,df->bsf", x, w_up)
        h = _sigmoid(g) * u
        return torch.einsum("bsf,fd->bsd", h, w_down)

    x = A_u
    xn = _layernorm(x, axis=-1)
    return x + _A_ref(xn, A_log_A_real, A_A_imag, A_C_real, A_C_imag, A_log_dt, A_D_skip) + _B_ref(xn, B_w_gate, B_w_up, B_w_down)
```

```asm
; @launch grid=(256,1,1) block=(512,1,1) lds=163840
.amdgcn_target "amdgcn-amd-amdhsa--gfx950"
.text
.globl parallel_sum__ssm_conv_s4d__glu_gated_glu__prompt_kernel
.p2align 8
.type parallel_sum__ssm_conv_s4d__glu_gated_glu__prompt_kernel,@function
parallel_sum__ssm_conv_s4d__glu_gated_glu__prompt_kernel:
  s_cmp_ge_u32 s2, 256
  s_cbranch_scc1 L_END
  s_load_dwordx16 s[64:79], s[0:1], 0
  s_load_dwordx8 s[80:87], s[0:1], 64
  s_load_dwordx4 s[88:91], s[0:1], 96
  v_lshrrev_b32 v2, 6, v0
  v_and_b32 v1, 63, v0
  v_readfirstlane_b32 s3, v2
  s_and_b32 s39, s2, 7
  s_lshr_b32 s40, s2, 3
  s_and_b32 s41, s39, 1
  s_lshr_b32 s42, s39, 1
  s_lshl_b32 s32, s41, 3
  s_and_b32 s43, s40, 7
  s_add_u32 s32, s32, s43
  s_lshr_b32 s44, s40, 3
  s_lshl_b32 s33, s42, 2
  s_add_u32 s33, s33, s44
  s_lshl_b32 s34, s44, 1
  s_add_u32 s34, s34, s43
  s_and_b32 s34, s34, 7
  s_lshl_b32 s35, s41, 7
  s_lshl_b32 s43, s42, 5
  s_add_u32 s35, s35, s43
  s_add_u32 s35, s35, s40
  v_lshrrev_b32 v2, 3, v1
  v_and_b32 v3, 7, v1
  v_lshrrev_b32 v4, 1, v2
  v_xor_b32 v3, v3, v4
  v_lshlrev_b32 v2, 10, v2
  v_lshlrev_b32 v4, 4, v3
  v_add_u32 v200, v2, v4
  v_xor_b32 v3, 4, v3
  v_lshlrev_b32 v4, 4, v3
  v_add_u32 v201, v2, v4
  v_lshrrev_b32 v2, 4, v1
  v_and_b32 v3, 15, v1
  s_movk_i32 s39, 2752
  v_mul_lo_u32 v5, v2, s39
  v_lshlrev_b32 v4, 2, v2
  v_sub_u32 v4, v3, v4
  v_and_b32 v4, 15, v4
  v_cmp_gt_u32 vcc, 12, v4
  v_lshlrev_b32 v4, 4, v4
  v_add_u32 v4, v5, v4
  v_mov_b32 v6, 0x7f000000
  v_cndmask_b32 v202, v6, v4, vcc
  v_lshlrev_b32 v4, 2, v2
  v_add_u32 v4, 2, v4
  v_sub_u32 v4, v3, v4
  v_and_b32 v4, 15, v4
  v_cmp_gt_u32 vcc, 12, v4
  v_lshlrev_b32 v4, 4, v4
  v_add_u32 v4, v5, v4
  v_mov_b32 v6, 0x7f000000
  v_cndmask_b32 v203, v6, v4, vcc
  s_waitcnt lgkmcnt(0)
  s_mov_b32 s4, s64
  s_and_b32 s5, s65, 0xffff
  s_mov_b32 s6, 2097152
  s_mov_b32 s7, 0x20000
  s_mov_b32 s8, s80
  s_and_b32 s9, s81, 0xffff
  s_mov_b32 s10, 1409024
  s_mov_b32 s11, 0x20000
  s_mov_b32 s12, s82
  s_and_b32 s13, s83, 0xffff
  s_mov_b32 s14, 1409024
  s_mov_b32 s15, 0x20000
  s_mov_b32 s16, s90
  s_and_b32 s17, s91, 0xffff
  s_mov_b32 s18, 268435456
  s_mov_b32 s19, 0x20000
  v_mov_b32 v254, 0
  s_mov_b32 s40, 12701696
  buffer_load_dword v254, v254, s[16:19], s40 offen sc1
  s_cmp_ge_u32 s3, 4
  s_cbranch_scc1 L_NOLN_1
  s_lshl_b32 s40, s35, 3
  s_lshl_b32 s41, s3, 1
  s_add_u32 s40, s40, s41
  s_lshl_b32 s40, s40, 10
  v_lshlrev_b32 v2, 4, v1
  buffer_load_dwordx4 v[8:11], v2, s[4:7], s40 offen
  buffer_load_dwordx4 v[12:15], v2, s[4:7], s40 offen offset:1024
L_NOLN_1:
  s_cmp_eq_u32 s33, 15
  s_cbranch_scc1 L_NOINIT
  s_lshl_b32 s46, s32, 17
  s_lshl_b32 s42, s3, 14
  s_add_u32 s46, s46, s42
  s_mul_i32 s47, s3, 22016
  s_mul_i32 s44, s33, 192
  s_add_u32 s47, s47, s44
  s_lshl_b32 s43, s3, 11
  s_mov_b32 s40, s34
  s_mov_b32 s45, 0
L_DINIT:
  s_lshl_b32 s42, s40, 7
  s_add_u32 s41, s46, s42
  s_mul_i32 s42, s40, 176128
  s_add_u32 s42, s42, s47
  s_add_u32 m0, s43, 0
  s_nop 0
  buffer_load_dwordx4 v200, s[4:7], s41 offen lds
  s_add_u32 m0, s43, 1024
  s_add_u32 s41, s41, 8192
  buffer_load_dwordx4 v201, s[4:7], s41 offen lds
  s_add_u32 m0, s43, 16384
  s_nop 0
  buffer_load_dwordx4 v202, s[8:11], s42 offen lds
  s_add_u32 m0, s43, 32768
  s_nop 0
  buffer_load_dwordx4 v203, s[12:15], s42 offen lds
  s_add_u32 m0, s43, 17408
  s_add_u32 s42, s42, 11008
  buffer_load_dwordx4 v202, s[8:11], s42 offen lds
  s_add_u32 m0, s43, 33792
  s_nop 0
  buffer_load_dwordx4 v203, s[12:15], s42 offen lds
  s_add_u32 s40, s40, 1
  s_and_b32 s40, s40, 7
  s_add_u32 s43, s43, 49152
  s_add_u32 s45, s45, 1
  s_cmp_lt_u32 s45, 1
  s_cbranch_scc1 L_DINIT
L_NOINIT:
  s_and_b32 s39, s2, 7
  s_lshr_b32 s40, s2, 3
  s_lshl_b32 s36, s39, 5
  s_add_u32 s36, s36, s40
  s_lshl_b32 s37, s39, 2
  s_and_b32 s43, s40, 3
  s_add_u32 s37, s37, s43
  s_lshr_b32 s38, s40, 2
  s_mov_b32 s24, s86
  s_and_b32 s25, s87, 0xffff
  s_mov_b32 s26, 2097152
  s_mov_b32 s27, 0x20000
  s_cmp_lt_u32 s3, 6
  s_cbranch_scc1 L_NOPAR_2
  s_sub_u32 s48, s3, 6
  s_lshl_b32 s42, s36, 1
  s_add_u32 s42, s42, s48
  s_lshl_b32 s44, s42, 8
  v_lshlrev_b32 v3, 2, v1
  s_mov_b32 s28, s66
  s_and_b32 s29, s67, 0xffff
  s_mov_b32 s30, 131072
  s_mov_b32 s31, 0x20000
  buffer_load_dword v244, v3, s[28:31], s44 offen
  s_mov_b32 s28, s68
  s_and_b32 s29, s69, 0xffff
  s_mov_b32 s30, 131072
  s_mov_b32 s31, 0x20000
  buffer_load_dword v245, v3, s[28:31], s44 offen
  s_mov_b32 s28, s70
  s_and_b32 s29, s71, 0xffff
  s_mov_b32 s30, 131072
  s_mov_b32 s31, 0x20000
  buffer_load_dword v246, v3, s[28:31], s44 offen
  s_mov_b32 s28, s72
  s_and_b32 s29, s73, 0xffff
  s_mov_b32 s30, 131072
  s_mov_b32 s31, 0x20000
  buffer_load_dword v247, v3, s[28:31], s44 offen
  s_lshl_b32 s45, s36, 2
  s_load_dword s62, s[74:75], s45
L_NOPAR_2:
  s_cmp_ge_u32 s3, 4
  s_cbranch_scc1 L_NOG1S
  s_and_b32 s40, s3, 1
  s_lshr_b32 s41, s3, 1
  s_mul_i32 s42, s41, 3
  v_lshrrev_b32 v2, 4, v1
  v_and_b32 v3, 1, v2
  v_lshrrev_b32 v2, 1, v2
  v_lshrrev_b32 v4, 2, v1
  v_and_b32 v4, 3, v4
  v_lshlrev_b32 v5, 1, v4
  v_add_u32 v5, v5, v3
  v_add_u32 v5, s42, v5
  v_lshlrev_b32 v2, 3, v2
  v_add_u32 v2, v2, v4
  v_lshlrev_b32 v2, 8, v2
  v_lshlrev_b32 v3, 14, v3
  v_add_u32 v2, v2, v3
  v_and_b32 v4, 3, v1
  v_lshlrev_b32 v4, 3, v4
  v_add_u32 v2, v2, v4
  v_add_u32 v2, 16384, v2
  v_and_b32 v6, 7, v5
  v_lshl_add_u32 v60, v6, 5, v2
  v_add_u32 v5, 1, v5
  v_and_b32 v6, 7, v5
  v_lshl_add_u32 v61, v6, 5, v2
  v_add_u32 v5, 1, v5
  v_and_b32 v6, 7, v5
  v_lshl_add_u32 v62, v6, 5, v2
  v_and_b32 v2, 31, v1
  s_lshl_b32 s43, s40, 6
  v_add_u32 v2, s43, v2
  v_lshrrev_b32 v3, 5, v1
  v_lshrrev_b32 v4, 1, v2
  v_and_b32 v4, 7, v4
  v_xor_b32 v4, v4, v3
  v_lshlrev_b32 v2, 7, v2
  v_xor_b32 v5, 0, v4
  v_lshlrev_b32 v5, 4, v5
  v_add_u32 v56, v2, v5
  v_xor_b32 v5, 2, v4
  v_lshlrev_b32 v5, 4, v5
  v_add_u32 v57, v2, v5
  v_xor_b32 v5, 4, v4
  v_lshlrev_b32 v5, 4, v5
  v_add_u32 v58, v2, v5
  v_xor_b32 v5, 6, v4
  v_lshlrev_b32 v5, 4, v5
  v_add_u32 v59, v2, v5
  v_and_b32 v2, 15, v1
  v_lshrrev_b32 v3, 4, v1
  v_and_b32 v3, 1, v3
  v_cmp_eq_u32 vcc, v2, v3
  v_mov_b32 v4, 0x3f803f80
  v_mov_b32 v5, 0
  v_cndmask_b32 v64, v5, v4, vcc
  v_mov_b32 v65, v64
  v_mov_b32 v66, v64
  v_mov_b32 v67, v64
  v_mov_b32 v68, 0
  v_mov_b32 v69, 0
  v_mov_b32 v70, 0
  v_mov_b32 v71, 0
  v_mov_b32 v72, 0
  v_mov_b32 v73, 0
  v_mov_b32 v74, 0
  v_mov_b32 v75, 0
  v_mov_b32 v76, 0
  v_mov_b32 v77, 0
  v_mov_b32 v78, 0
  v_mov_b32 v79, 0
  s_cmp_eq_u32 s33, 15
  s_cbranch_scc1 L_LN_W0
  s_waitcnt vmcnt(6)
  s_branch L_LN_W1
L_LN_W0:
  s_waitcnt vmcnt(0)
L_LN_W1:
  v_add_u32 v254, 1, v254
  s_nop 0
  v_readfirstlane_b32 s63, v254
  v_lshlrev_b32 v16, 16, v8
  v_and_b32 v17, 0xffff0000, v8
  v_lshlrev_b32 v18, 16, v9
  v_and_b32 v19, 0xffff0000, v9
  v_lshlrev_b32 v20, 16, v10
  v_and_b32 v21, 0xffff0000, v10
  v_lshlrev_b32 v22, 16, v11
  v_and_b32 v23, 0xffff0000, v11
  v_lshlrev_b32 v24, 16, v12
  v_and_b32 v25, 0xffff0000, v12
  v_lshlrev_b32 v26, 16, v13
  v_and_b32 v27, 0xffff0000, v13
  v_lshlrev_b32 v28, 16, v14
  v_and_b32 v29, 0xffff0000, v14
  v_lshlrev_b32 v30, 16, v15
  v_and_b32 v31, 0xffff0000, v15
  v_add_f32 v32, v16, v17
  v_add_f32 v33, v24, v25
  v_add_f32 v32, v32, v18
  v_add_f32 v33, v33, v26
  v_add_f32 v32, v32, v19
  v_add_f32 v33, v33, v27
  v_add_f32 v32, v32, v20
  v_add_f32 v33, v33, v28
  v_add_f32 v32, v32, v21
  v_add_f32 v33, v33, v29
  v_add_f32 v32, v32, v22
  v_add_f32 v33, v33, v30
  v_add_f32 v32, v32, v23
  v_add_f32 v33, v33, v31
  s_nop 1
  v_add_f32_dpp v32, v32, v32 row_shr:1 row_mask:0xf bank_mask:0xf bound_ctrl:0
  v_add_f32_dpp v33, v33, v33 row_shr:1 row_mask:0xf bank_mask:0xf bound_ctrl:0
  s_nop 0
  v_add_f32_dpp v32, v32, v32 row_shr:2 row_mask:0xf bank_mask:0xf bound_ctrl:0
  v_add_f32_dpp v33, v33, v33 row_shr:2 row_mask:0xf bank_mask:0xf bound_ctrl:0
  s_nop 0
  v_add_f32_dpp v32, v32, v32 row_shr:4 row_mask:0xf bank_mask:0xf bound_ctrl:0
  v_add_f32_dpp v33, v33, v33 row_shr:4 row_mask:0xf bank_mask:0xf bound_ctrl:0
  s_nop 0
  v_add_f32_dpp v32, v32, v32 row_shr:8 row_mask:0xf bank_mask:0xf bound_ctrl:0
  v_add_f32_dpp v33, v33, v33 row_shr:8 row_mask:0xf bank_mask:0xf bound_ctrl:0
  s_nop 0
  v_add_f32_dpp v32, v32, v32 row_bcast:15 row_mask:0xa bank_mask:0xf
  v_add_f32_dpp v33, v33, v33 row_bcast:15 row_mask:0xa bank_mask:0xf
  s_nop 0
  v_add_f32_dpp v32, v32, v32 row_bcast:31 row_mask:0xc bank_mask:0xf
  v_add_f32_dpp v33, v33, v33 row_bcast:31 row_mask:0xc bank_mask:0xf
  s_nop 0
  v_readlane_b32 s50, v32, 63
  v_readlane_b32 s51, v33, 63
  v_mov_b32 v39, 0x3b000000
  s_nop 0
  v_mul_f32 v34, s50, v39
  v_mul_f32 v35, s51, v39
  v_cvt_pk_bf16_f32 v36, v34, v34
  v_cvt_pk_bf16_f32 v37, v35, v35
  v_and_b32 v36, 0xffff0000, v36
  v_and_b32 v37, 0xffff0000, v37
  v_sub_f32 v40, v16, v34
  v_sub_f32 v48, v24, v35
  v_sub_f32 v41, v17, v34
  v_sub_f32 v49, v25, v35
  v_sub_f32 v42, v18, v34
  v_sub_f32 v50, v26, v35
  v_sub_f32 v43, v19, v34
  v_sub_f32 v51, v27, v35
  v_sub_f32 v44, v20, v34
  v_sub_f32 v52, v28, v35
  v_sub_f32 v45, v21, v34
  v_sub_f32 v53, v29, v35
  v_sub_f32 v46, v22, v34
  v_sub_f32 v54, v30, v35
  v_sub_f32 v47, v23, v34
  v_sub_f32 v55, v31, v35
  v_mul_f32 v32, v40, v40
  v_mul_f32 v33, v48, v48
  v_fmac_f32 v32, v41, v41
  v_fmac_f32 v33, v49, v49
  v_fmac_f32 v32, v42, v42
  v_fmac_f32 v33, v50, v50
  v_fmac_f32 v32, v43, v43
  v_fmac_f32 v33, v51, v51
  v_fmac_f32 v32, v44, v44
  v_fmac_f32 v33, v52, v52
  v_fmac_f32 v32, v45, v45
  v_fmac_f32 v33, v53, v53
  v_fmac_f32 v32, v46, v46
  v_fmac_f32 v33, v54, v54
  v_fmac_f32 v32, v47, v47
  v_fmac_f32 v33, v55, v55
  s_nop 1
  v_add_f32_dpp v32, v32, v32 row_shr:1 row_mask:0xf bank_mask:0xf bound_ctrl:0
  v_add_f32_dpp v33, v33, v33 row_shr:1 row_mask:0xf bank_mask:0xf bound_ctrl:0
  s_nop 0
  v_add_f32_dpp v32, v32, v32 row_shr:2 row_mask:0xf bank_mask:0xf bound_ctrl:0
  v_add_f32_dpp v33, v33, v33 row_shr:2 row_mask:0xf bank_mask:0xf bound_ctrl:0
  s_nop 0
  v_add_f32_dpp v32, v32, v32 row_shr:4 row_mask:0xf bank_mask:0xf bound_ctrl:0
  v_add_f32_dpp v33, v33, v33 row_shr:4 row_mask:0xf bank_mask:0xf bound_ctrl:0
  s_nop 0
  v_add_f32_dpp v32, v32, v32 row_shr:8 row_mask:0xf bank_mask:0xf bound_ctrl:0
  v_add_f32_dpp v33, v33, v33 row_shr:8 row_mask:0xf bank_mask:0xf bound_ctrl:0
  s_nop 0
  v_add_f32_dpp v32, v32, v32 row_bcast:15 row_mask:0xa bank_mask:0xf
  v_add_f32_dpp v33, v33, v33 row_bcast:15 row_mask:0xa bank_mask:0xf
  s_nop 0
  v_add_f32_dpp v32, v32, v32 row_bcast:31 row_mask:0xc bank_mask:0xf
  v_add_f32_dpp v33, v33, v33 row_bcast:31 row_mask:0xc bank_mask:0xf
  s_nop 0
  v_readlane_b32 s50, v32, 63
  v_readlane_b32 s51, v33, 63
  s_nop 1
  v_mul_f32 v32, s50, v39
  v_mul_f32 v33, s51, v39
  v_cvt_pk_bf16_f32 v32, v32, v32
  v_cvt_pk_bf16_f32 v33, v33, v33
  v_and_b32 v32, 0xffff0000, v32
  v_and_b32 v33, 0xffff0000, v33
  v_add_f32 v32, 0x3727c5ac, v32
  v_add_f32 v33, 0x3727c5ac, v33
  v_cvt_pk_bf16_f32 v32, v32, v32
  v_cvt_pk_bf16_f32 v33, v33, v33
  v_and_b32 v32, 0xffff0000, v32
  v_and_b32 v33, 0xffff0000, v33
  v_sqrt_f32 v32, v32
  v_sqrt_f32 v33, v33
  s_nop 0
  v_cvt_pk_bf16_f32 v32, v32, v32
  v_cvt_pk_bf16_f32 v33, v33, v33
  v_and_b32 v32, 0xffff0000, v32
  v_and_b32 v33, 0xffff0000, v33
  v_rcp_f32 v32, v32
  v_rcp_f32 v33, v33
  s_nop 0
  v_sub_f32 v40, v16, v36
  v_sub_f32 v41, v17, v36
  v_sub_f32 v42, v18, v36
  v_sub_f32 v43, v19, v36
  v_sub_f32 v44, v20, v36
  v_sub_f32 v45, v21, v36
  v_sub_f32 v46, v22, v36
  v_sub_f32 v47, v23, v36
  v_cvt_pk_bf16_f32 v8, v40, v41
  v_cvt_pk_bf16_f32 v9, v42, v43
  v_cvt_pk_bf16_f32 v10, v44, v45
  v_cvt_pk_bf16_f32 v11, v46, v47
  v_lshlrev_b32 v40, 16, v8
  v_and_b32 v41, 0xffff0000, v8
  v_lshlrev_b32 v42, 16, v9
  v_and_b32 v43, 0xffff0000, v9
  v_lshlrev_b32 v44, 16, v10
  v_and_b32 v45, 0xffff0000, v10
  v_lshlrev_b32 v46, 16, v11
  v_and_b32 v47, 0xffff0000, v11
  v_mul_f32 v40, v40, v32
  v_mul_f32 v41, v41, v32
  v_mul_f32 v42, v42, v32
  v_mul_f32 v43, v43, v32
  v_mul_f32 v44, v44, v32
  v_mul_f32 v45, v45, v32
  v_mul_f32 v46, v46, v32
  v_mul_f32 v47, v47, v32
  v_cvt_pk_bf16_f32 v8, v40, v41
  v_cvt_pk_bf16_f32 v9, v42, v43
  v_cvt_pk_bf16_f32 v10, v44, v45
  v_cvt_pk_bf16_f32 v11, v46, v47
  v_sub_f32 v48, v24, v37
  v_sub_f32 v49, v25, v37
  v_sub_f32 v50, v26, v37
  v_sub_f32 v51, v27, v37
  v_sub_f32 v52, v28, v37
  v_sub_f32 v53, v29, v37
  v_sub_f32 v54, v30, v37
  v_sub_f32 v55, v31, v37
  v_cvt_pk_bf16_f32 v12, v48, v49
  v_cvt_pk_bf16_f32 v13, v50, v51
  v_cvt_pk_bf16_f32 v14, v52, v53
  v_cvt_pk_bf16_f32 v15, v54, v55
  v_lshlrev_b32 v48, 16, v12
  v_and_b32 v49, 0xffff0000, v12
  v_lshlrev_b32 v50, 16, v13
  v_and_b32 v51, 0xffff0000, v13
  v_lshlrev_b32 v52, 16, v14
  v_and_b32 v53, 0xffff0000, v14
  v_lshlrev_b32 v54, 16, v15
  v_and_b32 v55, 0xffff0000, v15
  v_mul_f32 v48, v48, v33
  v_mul_f32 v49, v49, v33
  v_mul_f32 v50, v50, v33
  v_mul_f32 v51, v51, v33
  v_mul_f32 v52, v52, v33
  v_mul_f32 v53, v53, v33
  v_mul_f32 v54, v54, v33
  v_mul_f32 v55, v55, v33
  v_cvt_pk_bf16_f32 v12, v48, v49
  v_cvt_pk_bf16_f32 v13, v50, v51
  v_cvt_pk_bf16_f32 v14, v52, v53
  v_cvt_pk_bf16_f32 v15, v54, v55
  s_mul_i32 s43, s3, 2176
  s_add_u32 s43, s43, 147456
  v_lshlrev_b32 v2, 4, v1
  v_add_u32 v2, s43, v2
  ds_write_b128 v2, v[8:11]
  ds_write_b128 v2, v[12:15] offset:1088
  v_mov_b32 v16, v36
  v_mov_b32 v17, v32
  v_mov_b32 v18, v37
  v_mov_b32 v19, v33
  s_lshl_b32 s43, s3, 4
  s_add_u32 s43, s43, 160960
  v_mov_b32 v2, s43
  s_mov_b64 exec, 1
  ds_write_b128 v2, v[16:19]
  s_mov_b64 exec, -1
L_NOG1S:
  s_cmp_lt_u32 s3, 4
  s_cselect_b32 s40, 3, 0
  s_cmp_ge_u32 s3, 6
  s_cbranch_scc1 L_LN
  s_setprio 3
  s_cmp_ge_u32 s3, 4
  s_cbranch_scc1 L_W45
  s_cmp_eq_u32 s33, 15
  s_cbranch_scc1 L_MISC03
  s_and_b32 s40, s3, 1
  s_lshr_b32 s41, s3, 1
  s_mul_i32 s42, s41, 3
  s_waitcnt vmcnt(0) lgkmcnt(0)
  s_mov_b32 s52, 0
  s_mov_b32 s53, 0
  s_mov_b32 s55, 4294868992
  s_mov_b32 s51, 49152
  s_barrier
  ds_read_b128 v[8:11], v56 offset:0
  ds_read_b128 v[12:15], v56 offset:4096
  ds_read_b64_tr_b16 v[204:205], v60 offset:0
  ds_read_b64_tr_b16 v[206:207], v60 offset:1024
  ds_read_b64_tr_b16 v[208:209], v61 offset:0
  ds_read_b64_tr_b16 v[210:211], v61 offset:1024
  ds_read_b64_tr_b16 v[212:213], v62 offset:0
  ds_read_b64_tr_b16 v[214:215], v62 offset:1024
  ds_read_b128 v[16:19], v57 offset:0
  ds_read_b128 v[20:23], v57 offset:4096
  ds_read_b64_tr_b16 v[216:217], v60 offset:4096
  ds_read_b64_tr_b16 v[218:219], v60 offset:5120
  ds_read_b64_tr_b16 v[220:221], v61 offset:4096
  ds_read_b64_tr_b16 v[222:223], v61 offset:5120
  ds_read_b64_tr_b16 v[224:225], v62 offset:4096
  ds_read_b64_tr_b16 v[226:227], v62 offset:5120
  s_waitcnt lgkmcnt(8)
  v_mfma_f32_32x32x16_bf16 v[100:115], v[204:207], v[8:11], 0
  ds_read_b128 v[24:27], v58 offset:0
  ds_read_b128 v[28:31], v58 offset:4096
  v_mfma_f32_32x32x16_bf16 v[116:131], v[204:207], v[12:15], 0
  ds_read_b64_tr_b16 v[228:229], v60 offset:8192
  ds_read_b64_tr_b16 v[230:231], v60 offset:9216
  v_mfma_f32_32x32x16_bf16 v[132:147], v[208:211], v[8:11], 0
  ds_read_b64_tr_b16 v[232:233], v61 offset:8192
  ds_read_b64_tr_b16 v[234:235], v61 offset:9216
  v_mfma_f32_32x32x16_bf16 v[148:163], v[208:211], v[12:15], 0
  ds_read_b64_tr_b16 v[236:237], v62 offset:8192
  ds_read_b64_tr_b16 v[238:239], v62 offset:9216
  v_mfma_f32_32x32x16_bf16 v[164:179], v[212:215], v[8:11], 0
  v_mfma_f32_32x32x16_bf16 v[180:195], v[212:215], v[12:15], 0
  s_waitcnt lgkmcnt(8)
  v_mfma_f32_32x32x16_bf16 v[100:115], v[216:219], v[16:19], v[100:115]
  ds_read_b128 v[32:35], v59 offset:0
  ds_read_b128 v[36:39], v59 offset:4096
  v_mfma_f32_32x32x16_bf16 v[116:131], v[216:219], v[20:23], v[116:131]
  ds_read_b64_tr_b16 v[240:241], v60 offset:12288
  ds_read_b64_tr_b16 v[242:243], v60 offset:13312
  v_mfma_f32_32x32x16_bf16 v[132:147], v[220:223], v[16:19], v[132:147]
  ds_read_b64_tr_b16 v[244:245], v61 offset:12288
  ds_read_b64_tr_b16 v[246:247], v61 offset:13312
  v_mfma_f32_32x32x16_bf16 v[148:163], v[220:223], v[20:23], v[148:163]
  ds_read_b64_tr_b16 v[248:249], v62 offset:12288
  ds_read_b64_tr_b16 v[250:251], v62 offset:13312
  v_mfma_f32_32x32x16_bf16 v[164:179], v[224:227], v[16:19], v[164:179]
  v_mfma_f32_32x32x16_bf16 v[180:195], v[224:227], v[20:23], v[180:195]
  s_xor_b32 s45, s40, 0
  s_or_b32 s45, s45, s52
  s_cmp_eq_u32 s45, 0
  s_cbranch_scc0 L_G1_CSR1
  v_mfma_f32_16x16x32_bf16 v[68:71], v[204:207], v[64:67], v[68:71]
  v_mfma_f32_16x16x32_bf16 v[72:75], v[208:211], v[64:67], v[72:75]
  v_mfma_f32_16x16x32_bf16 v[76:79], v[212:215], v[64:67], v[76:79]
  v_mfma_f32_16x16x32_bf16 v[68:71], v[216:219], v[64:67], v[68:71]
  v_mfma_f32_16x16x32_bf16 v[72:75], v[220:223], v[64:67], v[72:75]
  v_mfma_f32_16x16x32_bf16 v[76:79], v[224:227], v[64:67], v[76:79]
  v_and_b32 v2, 1, v1
  v_lshlrev_b32 v2, 6, v2
  v_lshrrev_b32 v3, 4, v1
  v_lshlrev_b32 v3, 4, v3
  v_add_u32 v2, v2, v3
  s_mul_i32 s43, s40, 768
  s_lshl_b32 s44, s42, 7
  s_add_u32 s43, s43, s44
  s_add_u32 s43, s43, 158592
  v_add_u32 v2, s43, v2
  s_mov_b32 exec_lo, 0x00030003
  s_mov_b32 exec_hi, 0x00030003
  s_nop 3
  ds_write_b128 v2, v[68:71] offset:0
  ds_write_b128 v2, v[72:75] offset:128
  ds_write_b128 v2, v[76:79] offset:256
  s_mov_b64 exec, -1
  s_waitcnt lgkmcnt(0)
L_G1_CSR1:
  s_waitcnt vmcnt(0) lgkmcnt(0)
  s_barrier
  s_add_u32 s53, s53, 1
  s_cmp_eq_u32 s53, 3
  s_cselect_b32 s54, s55, s51
  s_cselect_b32 s53, 0, s53
  v_add_u32 v56, s54, v56
  v_add_u32 v57, s54, v57
  v_add_u32 v58, s54, v58
  v_add_u32 v59, s54, v59
  v_add_u32 v60, s54, v60
  v_add_u32 v61, s54, v61
  v_add_u32 v62, s54, v62
  v_mfma_f32_32x32x16_bf16 v[100:115], v[228:231], v[24:27], v[100:115]
  ds_read_b128 v[8:11], v56 offset:0
  ds_read_b128 v[12:15], v56 offset:4096
  v_mfma_f32_32x32x16_bf16 v[116:131], v[228:231], v[28:31], v[116:131]
  ds_read_b64_tr_b16 v[204:205], v60 offset:0
  ds_read_b64_tr_b16 v[206:207], v60 offset:1024
  v_mfma_f32_32x32x16_bf16 v[132:147], v[232:235], v[24:27], v[132:147]
  ds_read_b64_tr_b16 v[208:209], v61 offset:0
  ds_read_b64_tr_b16 v[210:211], v61 offset:1024
  v_mfma_f32_32x32x16_bf16 v[148:163], v[232:235], v[28:31], v[148:163]
  ds_read_b64_tr_b16 v[212:213], v62 offset:0
  ds_read_b64_tr_b16 v[214:215], v62 offset:1024
  v_mfma_f32_32x32x16_bf16 v[164:179], v[236:239], v[24:27], v[164:179]
  v_mfma_f32_32x32x16_bf16 v[180:195], v[236:239], v[28:31], v[180:195]
  s_waitcnt lgkmcnt(8)
  v_mfma_f32_32x32x16_bf16 v[100:115], v[240:243], v[32:35], v[100:115]
  ds_read_b128 v[16:19], v57 offset:0
  ds_read_b128 v[20:23], v57 offset:4096
  v_mfma_f32_32x32x16_bf16 v[116:131], v[240:243], v[36:39], v[116:131]
  ds_read_b64_tr_b16 v[216:217], v60 offset:4096
  ds_read_b64_tr_b16 v[218:219], v60 offset:5120
  v_mfma_f32_32x32x16_bf16 v[132:147], v[244:247], v[32:35], v[132:147]
  ds_read_b64_tr_b16 v[220:221], v61 offset:4096
  ds_read_b64_tr_b16 v[222:223], v61 offset:5120
  v_mfma_f32_32x32x16_bf16 v[148:163], v[244:247], v[36:39], v[148:163]
  ds_read_b64_tr_b16 v[224:225], v62 offset:4096
  ds_read_b64_tr_b16 v[226:227], v62 offset:5120
  v_mfma_f32_32x32x16_bf16 v[164:179], v[248:251], v[32:35], v[164:179]
  v_mfma_f32_32x32x16_bf16 v[180:195], v[248:251], v[36:39], v[180:195]
  s_xor_b32 s45, s40, 1
  s_or_b32 s45, s45, s52
  s_cmp_eq_u32 s45, 0
  s_cbranch_scc0 L_G1_CSR3
  v_mfma_f32_16x16x32_bf16 v[68:71], v[228:231], v[64:67], v[68:71]
  v_mfma_f32_16x16x32_bf16 v[72:75], v[232:235], v[64:67], v[72:75]
  v_mfma_f32_16x16x32_bf16 v[76:79], v[236:239], v[64:67], v[76:79]
  v_mfma_f32_16x16x32_bf16 v[68:71], v[240:243], v[64:67], v[68:71]
  v_mfma_f32_16x16x32_bf16 v[72:75], v[244:247], v[64:67], v[72:75]
  v_mfma_f32_16x16x32_bf16 v[76:79], v[248:251], v[64:67], v[76:79]
  v_and_b32 v2, 1, v1
  v_lshlrev_b32 v2, 6, v2
  v_lshrrev_b32 v3, 4, v1
  v_lshlrev_b32 v3, 4, v3
  v_add_u32 v2, v2, v3
  s_mul_i32 s43, s40, 768
  s_lshl_b32 s44, s42, 7
  s_add_u32 s43, s43, s44
  s_add_u32 s43, s43, 158592
  v_add_u32 v2, s43, v2
  s_mov_b32 exec_lo, 0x00030003
  s_mov_b32 exec_hi, 0x00030003
  s_nop 3
  ds_write_b128 v2, v[68:71] offset:0
  ds_write_b128 v2, v[72:75] offset:128
  ds_write_b128 v2, v[76:79] offset:256
  s_mov_b64 exec, -1
  s_waitcnt lgkmcnt(0)
L_G1_CSR3:
  s_mov_b32 s52, 1
L_G1_LOOP:
  s_waitcnt lgkmcnt(8)
  v_mfma_f32_32x32x16_bf16 v[100:115], v[204:207], v[8:11], v[100:115]
  ds_read_b128 v[24:27], v58 offset:0
  ds_read_b128 v[28:31], v58 offset:4096
  v_mfma_f32_32x32x16_bf16 v[116:131], v[204:207], v[12:15], v[116:131]
  ds_read_b64_tr_b16 v[228:229], v60 offset:8192
  ds_read_b64_tr_b16 v[230:231], v60 offset:9216
  v_mfma_f32_32x32x16_bf16 v[132:147], v[208:211], v[8:11], v[132:147]
  ds_read_b64_tr_b16 v[232:233], v61 offset:8192
  ds_read_b64_tr_b16 v[234:235], v61 offset:9216
  v_mfma_f32_32x32x16_bf16 v[148:163], v[208:211], v[12:15], v[148:163]
  ds_read_b64_tr_b16 v[236:237], v62 offset:8192
  ds_read_b64_tr_b16 v[238:239], v62 offset:9216
  v_mfma_f32_32x32x16_bf16 v[164:179], v[212:215], v[8:11], v[164:179]
  v_mfma_f32_32x32x16_bf16 v[180:195], v[212:215], v[12:15], v[180:195]
  s_waitcnt lgkmcnt(8)
  v_mfma_f32_32x32x16_bf16 v[100:115], v[216:219], v[16:19], v[100:115]
  ds_read_b128 v[32:35], v59 offset:0
  ds_read_b128 v[36:39], v59 offset:4096
  v_mfma_f32_32x32x16_bf16 v[116:131], v[216:219], v[20:23], v[116:131]
  ds_read_b64_tr_b16 v[240:241], v60 offset:12288
  ds_read_b64_tr_b16 v[242:243], v60 offset:13312
  v_mfma_f32_32x32x16_bf16 v[132:147], v[220:223], v[16:19], v[132:147]
  ds_read_b64_tr_b16 v[244:245], v61 offset:12288
  ds_read_b64_tr_b16 v[246:247], v61 offset:13312
  v_mfma_f32_32x32x16_bf16 v[148:163], v[220:223], v[20:23], v[148:163]
  ds_read_b64_tr_b16 v[248:249], v62 offset:12288
  ds_read_b64_tr_b16 v[250:251], v62 offset:13312
  v_mfma_f32_32x32x16_bf16 v[164:179], v[224:227], v[16:19], v[164:179]
  v_mfma_f32_32x32x16_bf16 v[180:195], v[224:227], v[20:23], v[180:195]
  s_waitcnt lgkmcnt(0)
  s_barrier
  s_add_u32 s53, s53, 1
  s_cmp_eq_u32 s53, 3
  s_cselect_b32 s54, s55, s51
  s_cselect_b32 s53, 0, s53
  v_add_u32 v56, s54, v56
  v_add_u32 v57, s54, v57
  v_add_u32 v58, s54, v58
  v_add_u32 v59, s54, v59
  v_add_u32 v60, s54, v60
  v_add_u32 v61, s54, v61
  v_add_u32 v62, s54, v62
  v_mfma_f32_32x32x16_bf16 v[100:115], v[228:231], v[24:27], v[100:115]
  ds_read_b128 v[8:11], v56 offset:0
  ds_read_b128 v[12:15], v56 offset:4096
  v_mfma_f32_32x32x16_bf16 v[116:131], v[228:231], v[28:31], v[116:131]
  ds_read_b64_tr_b16 v[204:205], v60 offset:0
  ds_read_b64_tr_b16 v[206:207], v60 offset:1024
  v_mfma_f32_32x32x16_bf16 v[132:147], v[232:235], v[24:27], v[132:147]
  ds_read_b64_tr_b16 v[208:209], v61 offset:0
  ds_read_b64_tr_b16 v[210:211], v61 offset:1024
  v_mfma_f32_32x32x16_bf16 v[148:163], v[232:235], v[28:31], v[148:163]
  ds_read_b64_tr_b16 v[212:213], v62 offset:0
  ds_read_b64_tr_b16 v[214:215], v62 offset:1024
  v_mfma_f32_32x32x16_bf16 v[164:179], v[236:239], v[24:27], v[164:179]
  v_mfma_f32_32x32x16_bf16 v[180:195], v[236:239], v[28:31], v[180:195]
  s_waitcnt lgkmcnt(8)
  v_mfma_f32_32x32x16_bf16 v[100:115], v[240:243], v[32:35], v[100:115]
  ds_read_b128 v[16:19], v57 offset:0
  ds_read_b128 v[20:23], v57 offset:4096
  v_mfma_f32_32x32x16_bf16 v[116:131], v[240:243], v[36:39], v[116:131]
  ds_read_b64_tr_b16 v[216:217], v60 offset:4096
  ds_read_b64_tr_b16 v[218:219], v60 offset:5120
  v_mfma_f32_32x32x16_bf16 v[132:147], v[244:247], v[32:35], v[132:147]
  ds_read_b64_tr_b16 v[220:221], v61 offset:4096
  ds_read_b64_tr_b16 v[222:223], v61 offset:5120
  v_mfma_f32_32x32x16_bf16 v[148:163], v[244:247], v[36:39], v[148:163]
  ds_read_b64_tr_b16 v[224:225], v62 offset:4096
  ds_read_b64_tr_b16 v[226:227], v62 offset:5120
  v_mfma_f32_32x32x16_bf16 v[164:179], v[248:251], v[32:35], v[164:179]
  v_mfma_f32_32x32x16_bf16 v[180:195], v[248:251], v[36:39], v[180:195]
L_G1_SIDE:
  s_add_u32 s52, s52, 1
  s_cmp_lt_u32 s52, 8
  s_cbranch_scc1 L_G1_LOOP
  s_waitcnt lgkmcnt(0)
  s_barrier
  v_and_b32 v2, 31, v1
  s_lshl_b32 s43, s40, 6
  v_add_u32 v2, s43, v2
  v_lshlrev_b32 v2, 3, v2
  v_add_u32 v2, 157568, v2
  ds_read_b64 v[24:25], v2
  ds_read_b64 v[26:27], v2 offset:256
  s_mov_b32 s46, 1.0
  s_mov_b32 s47, 1.0
  v_lshrrev_b32 v3, 5, v1
  v_lshlrev_b32 v3, 4, v3
  s_lshl_b32 s45, s42, 7
  s_add_u32 s45, s45, 160128
  v_add_u32 v3, s45, v3
  ds_read_b128 v[40:43], v3 offset:0
  ds_read_b128 v[44:47], v3 offset:32
  ds_read_b128 v[48:51], v3 offset:64
  ds_read_b128 v[52:55], v3 offset:96
  ds_read_b128 v[56:59], v3 offset:128
  ds_read_b128 v[60:63], v3 offset:160
  ds_read_b128 v[64:67], v3 offset:192
  ds_read_b128 v[68:71], v3 offset:224
  ds_read_b128 v[72:75], v3 offset:256
  ds_read_b128 v[76:79], v3 offset:288
  ds_read_b128 v[80:83], v3 offset:320
  ds_read_b128 v[84:87], v3 offset:352
  v_lshlrev_b32 v4, 4, v1
  s_mul_i32 s48, s33, 6
  s_add_u32 s48, s48, s42
  s_lshl_b32 s49, s32, 2
  s_lshl_b32 s50, s40, 1
  s_add_u32 s49, s49, s50
  s_mul_i32 s49, s49, 86
  s_add_u32 s49, s49, s48
  s_lshl_b32 s49, s49, 10
  s_add_u32 s49, s49, 2097152
  s_waitcnt lgkmcnt(0)
  v_mul_f32 v28, 0xbfb8aa3b, v25
  v_mul_f32 v29, 0xbfb8aa3b, v27
  v_fma_f32 v100, -v24, v40, v100
  v_fma_f32 v101, -v24, v41, v101
  v_fma_f32 v102, -v24, v42, v102
  v_fma_f32 v103, -v24, v43, v103
  v_fma_f32 v104, -v24, v44, v104
  v_fma_f32 v105, -v24, v45, v105
  v_fma_f32 v106, -v24, v46, v106
  v_fma_f32 v107, -v24, v47, v107
  v_mul_f32 v100, v100, v28
  v_mul_f32 v101, v101, v28
  v_mul_f32 v102, v102, v28
  v_mul_f32 v103, v103, v28
  v_mul_f32 v104, v104, v28
  v_mul_f32 v105, v105, v28
  v_mul_f32 v106, v106, v28
  v_mul_f32 v107, v107, v28
  v_exp_f32 v100, v100
  v_fma_f32 v108, -v24, v48, v108
  v_exp_f32 v101, v101
  v_fma_f32 v109, -v24, v49, v109
  v_exp_f32 v102, v102
  v_fma_f32 v110, -v24, v50, v110
  v_exp_f32 v103, v103
  v_fma_f32 v111, -v24, v51, v111
  v_exp_f32 v104, v104
  v_fma_f32 v112, -v24, v52, v112
  v_exp_f32 v105, v105
  v_fma_f32 v113, -v24, v53, v113
  v_exp_f32 v106, v106
  v_fma_f32 v114, -v24, v54, v114
  v_exp_f32 v107, v107
  v_fma_f32 v115, -v24, v55, v115
  v_add_f32 v100, 1.0, v100
  v_add_f32 v101, 1.0, v101
  v_add_f32 v102, 1.0, v102
  v_add_f32 v103, 1.0, v103
  v_add_f32 v104, 1.0, v104
  v_add_f32 v105, 1.0, v105
  v_add_f32 v106, 1.0, v106
  v_add_f32 v107, 1.0, v107
  v_rcp_f32 v100, v100
  v_rcp_f32 v101, v101
  v_rcp_f32 v102, v102
  v_rcp_f32 v103, v103
  v_rcp_f32 v104, v104
  v_rcp_f32 v105, v105
  v_rcp_f32 v106, v106
  v_rcp_f32 v107, v107
  s_nop 0
  v_mul_f32 v108, v108, v100
  v_mul_f32 v109, v109, v101
  v_mul_f32 v110, v110, v102
  v_mul_f32 v111, v111, v103
  v_mul_f32 v112, v112, v104
  v_mul_f32 v113, v113, v105
  v_mul_f32 v114, v114, v106
  v_mul_f32 v115, v115, v107
  v_cvt_pk_bf16_f32 v32, v108, v109
  v_cvt_pk_bf16_f32 v33, v110, v111
  v_cvt_pk_bf16_f32 v34, v112, v113
  v_cvt_pk_bf16_f32 v35, v114, v115
  s_add_u32 s50, s48, 0
  s_cmp_ge_u32 s50, 86
  s_cbranch_scc1 L_NOH_3
  s_add_u32 s50, s49, 0
  buffer_store_dwordx4 v[32:35], v4, s[16:19], s50 offen sc1
L_NOH_3:
  v_fma_f32 v116, -v26, v40, v116
  v_fma_f32 v117, -v26, v41, v117
  v_fma_f32 v118, -v26, v42, v118
  v_fma_f32 v119, -v26, v43, v119
  v_fma_f32 v120, -v26, v44, v120
  v_fma_f32 v121, -v26, v45, v121
  v_fma_f32 v122, -v26, v46, v122
  v_fma_f32 v123, -v26, v47, v123
  v_mul_f32 v116, v116, v29
  v_mul_f32 v117, v117, v29
  v_mul_f32 v118, v118, v29
  v_mul_f32 v119, v119, v29
  v_mul_f32 v120, v120, v29
  v_mul_f32 v121, v121, v29
  v_mul_f32 v122, v122, v29
  v_mul_f32 v123, v123, v29
  v_exp_f32 v116, v116
  v_fma_f32 v124, -v26, v48, v124
  v_exp_f32 v117, v117
  v_fma_f32 v125, -v26, v49, v125
  v_exp_f32 v118, v118
  v_fma_f32 v126, -v26, v50, v126
  v_exp_f32 v119, v119
  v_fma_f32 v127, -v26, v51, v127
  v_exp_f32 v120, v120
  v_fma_f32 v128, -v26, v52, v128
  v_exp_f32 v121, v121
  v_fma_f32 v129, -v26, v53, v129
  v_exp_f32 v122, v122
  v_fma_f32 v130, -v26, v54, v130
  v_exp_f32 v123, v123
  v_fma_f32 v131, -v26, v55, v131
  v_add_f32 v116, 1.0, v116
  v_add_f32 v117, 1.0, v117
  v_add_f32 v118, 1.0, v118
  v_add_f32 v119, 1.0, v119
  v_add_f32 v120, 1.0, v120
  v_add_f32 v121, 1.0, v121
  v_add_f32 v122, 1.0, v122
  v_add_f32 v123, 1.0, v123
  v_rcp_f32 v116, v116
  v_rcp_f32 v117, v117
  v_rcp_f32 v118, v118
  v_rcp_f32 v119, v119
  v_rcp_f32 v120, v120
  v_rcp_f32 v121, v121
  v_rcp_f32 v122, v122
  v_rcp_f32 v123, v123
  s_nop 0
  v_mul_f32 v124, v124, v116
  v_mul_f32 v125, v125, v117
  v_mul_f32 v126, v126, v118
  v_mul_f32 v127, v127, v119
  v_mul_f32 v128, v128, v120
  v_mul_f32 v129, v129, v121
  v_mul_f32 v130, v130, v122
  v_mul_f32 v131, v131, v123
  v_cvt_pk_bf16_f32 v36, v124, v125
  v_cvt_pk_bf16_f32 v37, v126, v127
  v_cvt_pk_bf16_f32 v38, v128, v129
  v_cvt_pk_bf16_f32 v39, v130, v131
  s_add_u32 s50, s48, 0
  s_cmp_ge_u32 s50, 86
  s_cbranch_scc1 L_NOH_4
  s_add_u32 s50, s49, 88064
  buffer_store_dwordx4 v[36:39], v4, s[16:19], s50 offen sc1
L_NOH_4:
  v_fma_f32 v132, -v24, v56, v132
  v_fma_f32 v133, -v24, v57, v133
  v_fma_f32 v134, -v24, v58, v134
  v_fma_f32 v135, -v24, v59, v135
  v_fma_f32 v136, -v24, v60, v136
  v_fma_f32 v137, -v24, v61, v137
  v_fma_f32 v138, -v24, v62, v138
  v_fma_f32 v139, -v24, v63, v139
  v_mul_f32 v132, v132, v28
  v_mul_f32 v133, v133, v28
  v_mul_f32 v134, v134, v28
  v_mul_f32 v135, v135, v28
  v_mul_f32 v136, v136, v28
  v_mul_f32 v137, v137, v28
  v_mul_f32 v138, v138, v28
  v_mul_f32 v139, v139, v28
  v_exp_f32 v132, v132
  v_fma_f32 v140, -v24, v64, v140
  v_exp_f32 v133, v133
  v_fma_f32 v141, -v24, v65, v141
  v_exp_f32 v134, v134
  v_fma_f32 v142, -v24, v66, v142
  v_exp_f32 v135, v135
  v_fma_f32 v143, -v24, v67, v143
  v_exp_f32 v136, v136
  v_fma_f32 v144, -v24, v68, v144
  v_exp_f32 v137, v137
  v_fma_f32 v145, -v24, v69, v145
  v_exp_f32 v138, v138
  v_fma_f32 v146, -v24, v70, v146
  v_exp_f32 v139, v139
  v_fma_f32 v147, -v24, v71, v147
  v_add_f32 v132, 1.0, v132
  v_add_f32 v133, 1.0, v133
  v_add_f32 v134, 1.0, v134
  v_add_f32 v135, 1.0, v135
  v_add_f32 v136, 1.0, v136
  v_add_f32 v137, 1.0, v137
  v_add_f32 v138, 1.0, v138
  v_add_f32 v139, 1.0, v139
  v_rcp_f32 v132, v132
  v_rcp_f32 v133, v133
  v_rcp_f32 v134, v134
  v_rcp_f32 v135, v135
  v_rcp_f32 v136, v136
  v_rcp_f32 v137, v137
  v_rcp_f32 v138, v138
  v_rcp_f32 v139, v139
  s_nop 0
  v_mul_f32 v140, v140, v132
  v_mul_f32 v141, v141, v133
  v_mul_f32 v142, v142, v134
  v_mul_f32 v143, v143, v135
  v_mul_f32 v144, v144, v136
  v_mul_f32 v145, v145, v137
  v_mul_f32 v146, v146, v138
  v_mul_f32 v147, v147, v139
  v_cvt_pk_bf16_f32 v32, v140, v141
  v_cvt_pk_bf16_f32 v33, v142, v143
  v_cvt_pk_bf16_f32 v34, v144, v145
  v_cvt_pk_bf16_f32 v35, v146, v147
  s_add_u32 s50, s48, 1
  s_cmp_ge_u32 s50, 86
  s_cbranch_scc1 L_NOH_5
  s_add_u32 s50, s49, 1024
  buffer_store_dwordx4 v[32:35], v4, s[16:19], s50 offen sc1
L_NOH_5:
  v_fma_f32 v148, -v26, v56, v148
  v_fma_f32 v149, -v26, v57, v149
  v_fma_f32 v150, -v26, v58, v150
  v_fma_f32 v151, -v26, v59, v151
  v_fma_f32 v152, -v26, v60, v152
  v_fma_f32 v153, -v26, v61, v153
  v_fma_f32 v154, -v26, v62, v154
  v_fma_f32 v155, -v26, v63, v155
  v_mul_f32 v148, v148, v29
  v_mul_f32 v149, v149, v29
  v_mul_f32 v150, v150, v29
  v_mul_f32 v151, v151, v29
  v_mul_f32 v152, v152, v29
  v_mul_f32 v153, v153, v29
  v_mul_f32 v154, v154, v29
  v_mul_f32 v155, v155, v29
  v_exp_f32 v148, v148
  v_fma_f32 v156, -v26, v64, v156
  v_exp_f32 v149, v149
  v_fma_f32 v157, -v26, v65, v157
  v_exp_f32 v150, v150
  v_fma_f32 v158, -v26, v66, v158
  v_exp_f32 v151, v151
  v_fma_f32 v159, -v26, v67, v159
  v_exp_f32 v152, v152
  v_fma_f32 v160, -v26, v68, v160
  v_exp_f32 v153, v153
  v_fma_f32 v161, -v26, v69, v161
  v_exp_f32 v154, v154
  v_fma_f32 v162, -v26, v70, v162
  v_exp_f32 v155, v155
  v_fma_f32 v163, -v26, v71, v163
  v_add_f32 v148, 1.0, v148
  v_add_f32 v149, 1.0, v149
  v_add_f32 v150, 1.0, v150
  v_add_f32 v151, 1.0, v151
  v_add_f32 v152, 1.0, v152
  v_add_f32 v153, 1.0, v153
  v_add_f32 v154, 1.0, v154
  v_add_f32 v155, 1.0, v155
  v_rcp_f32 v148, v148
  v_rcp_f32 v149, v149
  v_rcp_f32 v150, v150
  v_rcp_f32 v151, v151
  v_rcp_f32 v152, v152
  v_rcp_f32 v153, v153
  v_rcp_f32 v154, v154
  v_rcp_f32 v155, v155
  s_nop 0
  v_mul_f32 v156, v156, v148
  v_mul_f32 v157, v157, v149
  v_mul_f32 v158, v158, v150
  v_mul_f32 v159, v159, v151
  v_mul_f32 v160, v160, v152
  v_mul_f32 v161, v161, v153
  v_mul_f32 v162, v162, v154
  v_mul_f32 v163, v163, v155
  v_cvt_pk_bf16_f32 v36, v156, v157
  v_cvt_pk_bf16_f32 v37, v158, v159
  v_cvt_pk_bf16_f32 v38, v160, v161
  v_cvt_pk_bf16_f32 v39, v162, v163
  s_add_u32 s50, s48, 1
  s_cmp_ge_u32 s50, 86
  s_cbranch_scc1 L_NOH_6
  s_add_u32 s50, s49, 89088
  buffer_store_dwordx4 v[36:39], v4, s[16:19], s50 offen sc1
L_NOH_6:
  v_fma_f32 v164, -v24, v72, v164
  v_fma_f32 v165, -v24, v73, v165
  v_fma_f32 v166, -v24, v74, v166
  v_fma_f32 v167, -v24, v75, v167
  v_fma_f32 v168, -v24, v76, v168
  v_fma_f32 v169, -v24, v77, v169
  v_fma_f32 v170, -v24, v78, v170
  v_fma_f32 v171, -v24, v79, v171
  v_mul_f32 v164, v164, v28
  v_mul_f32 v165, v165, v28
  v_mul_f32 v166, v166, v28
  v_mul_f32 v167, v167, v28
  v_mul_f32 v168, v168, v28
  v_mul_f32 v169, v169, v28
  v_mul_f32 v170, v170, v28
  v_mul_f32 v171, v171, v28
  v_exp_f32 v164, v164
  v_fma_f32 v172, -v24, v80, v172
  v_exp_f32 v165, v165
  v_fma_f32 v173, -v24, v81, v173
  v_exp_f32 v166, v166
  v_fma_f32 v174, -v24, v82, v174
  v_exp_f32 v167, v167
  v_fma_f32 v175, -v24, v83, v175
  v_exp_f32 v168, v168
  v_fma_f32 v176, -v24, v84, v176
  v_exp_f32 v169, v169
  v_fma_f32 v177, -v24, v85, v177
  v_exp_f32 v170, v170
  v_fma_f32 v178, -v24, v86, v178
  v_exp_f32 v171, v171
  v_fma_f32 v179, -v24, v87, v179
  v_add_f32 v164, 1.0, v164
  v_add_f32 v165, 1.0, v165
  v_add_f32 v166, 1.0, v166
  v_add_f32 v167, 1.0, v167
  v_add_f32 v168, 1.0, v168
  v_add_f32 v169, 1.0, v169
  v_add_f32 v170, 1.0, v170
  v_add_f32 v171, 1.0, v171
  v_rcp_f32 v164, v164
  v_rcp_f32 v165, v165
  v_rcp_f32 v166, v166
  v_rcp_f32 v167, v167
  v_rcp_f32 v168, v168
  v_rcp_f32 v169, v169
  v_rcp_f32 v170, v170
  v_rcp_f32 v171, v171
  s_nop 0
  v_mul_f32 v172, v172, v164
  v_mul_f32 v173, v173, v165
  v_mul_f32 v174, v174, v166
  v_mul_f32 v175, v175, v167
  v_mul_f32 v176, v176, v168
  v_mul_f32 v177, v177, v169
  v_mul_f32 v178, v178, v170
  v_mul_f32 v179, v179, v171
  v_cvt_pk_bf16_f32 v32, v172, v173
  v_cvt_pk_bf16_f32 v33, v174, v175
  v_cvt_pk_bf16_f32 v34, v176, v177
  v_cvt_pk_bf16_f32 v35, v178, v179
  s_add_u32 s50, s48, 2
  s_cmp_ge_u32 s50, 86
  s_cbranch_scc1 L_NOH_7
  s_add_u32 s50, s49, 2048
  buffer_store_dwordx4 v[32:35], v4, s[16:19], s50 offen sc1
L_NOH_7:
  v_fma_f32 v180, -v26, v72, v180
  v_fma_f32 v181, -v26, v73, v181
  v_fma_f32 v182, -v26, v74, v182
  v_fma_f32 v183, -v26, v75, v183
  v_fma_f32 v184, -v26, v76, v184
  v_fma_f32 v185, -v26, v77, v185
  v_fma_f32 v186, -v26, v78, v186
  v_fma_f32 v187, -v26, v79, v187
  v_mul_f32 v180, v180, v29
  v_mul_f32 v181, v181, v29
  v_mul_f32 v182, v182, v29
  v_mul_f32 v183, v183, v29
  v_mul_f32 v184, v184, v29
  v_mul_f32 v185, v185, v29
  v_mul_f32 v186, v186, v29
  v_mul_f32 v187, v187, v29
  v_exp_f32 v180, v180
  v_fma_f32 v188, -v26, v80, v188
  v_exp_f32 v181, v181
  v_fma_f32 v189, -v26, v81, v189
  v_exp_f32 v182, v182
  v_fma_f32 v190, -v26, v82, v190
  v_exp_f32 v183, v183
  v_fma_f32 v191, -v26, v83, v191
  v_exp_f32 v184, v184
  v_fma_f32 v192, -v26, v84, v192
  v_exp_f32 v185, v185
  v_fma_f32 v193, -v26, v85, v193
  v_exp_f32 v186, v186
  v_fma_f32 v194, -v26, v86, v194
  v_exp_f32 v187, v187
  v_fma_f32 v195, -v26, v87, v195
  v_add_f32 v180, 1.0, v180
  v_add_f32 v181, 1.0, v181
  v_add_f32 v182, 1.0, v182
  v_add_f32 v183, 1.0, v183
  v_add_f32 v184, 1.0, v184
  v_add_f32 v185, 1.0, v185
  v_add_f32 v186, 1.0, v186
  v_add_f32 v187, 1.0, v187
  v_rcp_f32 v180, v180
  v_rcp_f32 v181, v181
  v_rcp_f32 v182, v182
  v_rcp_f32 v183, v183
  v_rcp_f32 v184, v184
  v_rcp_f32 v185, v185
  v_rcp_f32 v186, v186
  v_rcp_f32 v187, v187
  s_nop 0
  v_mul_f32 v188, v188, v180
  v_mul_f32 v189, v189, v181
  v_mul_f32 v190, v190, v182
  v_mul_f32 v191, v191, v183
  v_mul_f32 v192, v192, v184
  v_mul_f32 v193, v193, v185
  v_mul_f32 v194, v194, v186
  v_mul_f32 v195, v195, v187
  v_cvt_pk_bf16_f32 v36, v188, v189
  v_cvt_pk_bf16_f32 v37, v190, v191
  v_cvt_pk_bf16_f32 v38, v192, v193
  v_cvt_pk_bf16_f32 v39, v194, v195
  s_add_u32 s50, s48, 2
  s_cmp_ge_u32 s50, 86
  s_cbranch_scc1 L_NOH_8
  s_add_u32 s50, s49, 90112
  buffer_store_dwordx4 v[36:39], v4, s[16:19], s50 offen sc1
L_NOH_8:
  s_branch L_POST1
L_MISC03:
  s_waitcnt lgkmcnt(0)
  s_barrier
  s_mov_b32 s28, s84
  s_and_b32 s29, s85, 0xffff
  s_mov_b32 s30, 1409024
  s_mov_b32 s31, 0x20000
  s_mul_i32 s40, s32, 88064
  s_lshl_b32 s41, s3, 10
  s_add_u32 s40, s40, s41
  v_lshlrev_b32 v2, 4, v1
  buffer_load_dwordx4 v[8:11], v2, s[28:31], s40 offen
  s_add_u32 s40, s40, 4096
  buffer_load_dwordx4 v[12:15], v2, s[28:31], s40 offen
  s_add_u32 s40, s40, 4096
  buffer_load_dwordx4 v[16:19], v2, s[28:31], s40 offen
  s_add_u32 s40, s40, 4096
  buffer_load_dwordx4 v[20:23], v2, s[28:31], s40 offen
  s_add_u32 s40, s40, 4096
  buffer_load_dwordx4 v[24:27], v2, s[28:31], s40 offen
  s_add_u32 s40, s40, 4096
  buffer_load_dwordx4 v[28:31], v2, s[28:31], s40 offen
  s_add_u32 s40, s40, 4096
  buffer_load_dwordx4 v[32:35], v2, s[28:31], s40 offen
  s_add_u32 s40, s40, 4096
  buffer_load_dwordx4 v[36:39], v2, s[28:31], s40 offen
  s_add_u32 s40, s40, 4096
  buffer_load_dwordx4 v[40:43], v2, s[28:31], s40 offen
  s_add_u32 s40, s40, 4096
  buffer_load_dwordx4 v[44:47], v2, s[28:31], s40 offen
  s_add_u32 s40, s40, 4096
  buffer_load_dwordx4 v[48:51], v2, s[28:31], s40 offen
  s_add_u32 s40, s40, 4096
  buffer_load_dwordx4 v[52:55], v2, s[28:31], s40 offen
  s_add_u32 s40, s40, 4096
  buffer_load_dwordx4 v[56:59], v2, s[28:31], s40 offen
  s_add_u32 s40, s40, 4096
  buffer_load_dwordx4 v[60:63], v2, s[28:31], s40 offen
  s_add_u32 s40, s40, 4096
  buffer_load_dwordx4 v[64:67], v2, s[28:31], s40 offen
  s_add_u32 s40, s40, 4096
  buffer_load_dwordx4 v[68:71], v2, s[28:31], s40 offen
  s_add_u32 s40, s40, 4096
  buffer_load_dwordx4 v[8:11], v2, s[28:31], s40 offen
  s_add_u32 s40, s40, 4096
  buffer_load_dwordx4 v[12:15], v2, s[28:31], s40 offen
  s_add_u32 s40, s40, 4096
  buffer_load_dwordx4 v[16:19], v2, s[28:31], s40 offen
  s_add_u32 s40, s40, 4096
  buffer_load_dwordx4 v[20:23], v2, s[28:31], s40 offen
  s_add_u32 s40, s40, 4096
  buffer_load_dwordx4 v[24:27], v2, s[28:31], s40 offen
  s_add_u32 s40, s40, 4096
  buffer_load_dwordx4 v[28:31], v2, s[28:31], s40 offen
  s_add_u32 s40, s40, 4096
  s_barrier
  s_barrier
  s_barrier
  s_barrier
  s_barrier
  s_barrier
  s_barrier
  s_barrier
  s_barrier
  s_waitcnt vmcnt(0)
  s_branch L_POST1
L_W45:
  s_cmp_eq_u32 s33, 15
  s_cbranch_scc0 L_W45G
  v_and_b32 v4, 255, v0
  v_lshlrev_b32 v4, 3, v4
  v_subrev_u32 v5, 3, v4
  v_cvt_f32_u32 v6, v5
  v_cmp_gt_u32 vcc, 128, v5
  v_cvt_pk_bf16_f32 v6, v6, v6
  v_and_b32 v6, 0xffff, v6
  v_subrev_u32 v6, 0x4280, v6
  v_cndmask_b32 v6, v6, v5, vcc
  v_cmp_gt_i32 vcc, 0, v5
  v_mov_b32 v7, 661
  s_nop 0
  v_cndmask_b32 v6, v6, v7, vcc
  v_lshlrev_b32 v6, 1, v6
  v_add_u32 v120, 161024, v6
  v_subrev_u32 v5, 2, v4
  v_cvt_f32_u32 v6, v5
  v_cmp_gt_u32 vcc, 128, v5
  v_cvt_pk_bf16_f32 v6, v6, v6
  v_and_b32 v6, 0xffff, v6
  v_subrev_u32 v6, 0x4280, v6
  v_cndmask_b32 v6, v6, v5, vcc
  v_cmp_gt_i32 vcc, 0, v5
  v_mov_b32 v7, 661
  s_nop 0
  v_cndmask_b32 v6, v6, v7, vcc
  v_lshlrev_b32 v6, 1, v6
  v_add_u32 v121, 161024, v6
  v_subrev_u32 v5, 1, v4
  v_cvt_f32_u32 v6, v5
  v_cmp_gt_u32 vcc, 128, v5
  v_cvt_pk_bf16_f32 v6, v6, v6
  v_and_b32 v6, 0xffff, v6
  v_subrev_u32 v6, 0x4280, v6
  v_cndmask_b32 v6, v6, v5, vcc
  v_cmp_gt_i32 vcc, 0, v5
  v_mov_b32 v7, 661
  s_nop 0
  v_cndmask_b32 v6, v6, v7, vcc
  v_lshlrev_b32 v6, 1, v6
  v_add_u32 v122, 161024, v6
  v_add_u32 v5, 0, v4
  v_cvt_f32_u32 v6, v5
  v_cmp_gt_u32 vcc, 128, v5
  v_cvt_pk_bf16_f32 v6, v6, v6
  v_and_b32 v6, 0xffff, v6
  v_subrev_u32 v6, 0x4280, v6
  v_cndmask_b32 v6, v6, v5, vcc
  v_lshlrev_b32 v6, 1, v6
  v_add_u32 v123, 161024, v6
  v_add_u32 v5, 1, v4
  v_cvt_f32_u32 v6, v5
  v_cmp_gt_u32 vcc, 128, v5
  v_cvt_pk_bf16_f32 v6, v6, v6
  v_and_b32 v6, 0xffff, v6
  v_subrev_u32 v6, 0x4280, v6
  v_cndmask_b32 v6, v6, v5, vcc
  v_lshlrev_b32 v6, 1, v6
  v_add_u32 v124, 161024, v6
  v_add_u32 v5, 2, v4
  v_cvt_f32_u32 v6, v5
  v_cmp_gt_u32 vcc, 128, v5
  v_cvt_pk_bf16_f32 v6, v6, v6
  v_and_b32 v6, 0xffff, v6
  v_subrev_u32 v6, 0x4280, v6
  v_cndmask_b32 v6, v6, v5, vcc
  v_lshlrev_b32 v6, 1, v6
  v_add_u32 v125, 161024, v6
  v_add_u32 v5, 3, v4
  v_cvt_f32_u32 v6, v5
  v_cmp_gt_u32 vcc, 128, v5
  v_cvt_pk_bf16_f32 v6, v6, v6
  v_and_b32 v6, 0xffff, v6
  v_subrev_u32 v6, 0x4280, v6
  v_cndmask_b32 v6, v6, v5, vcc
  v_lshlrev_b32 v6, 1, v6
  v_add_u32 v126, 161024, v6
  v_add_u32 v5, 4, v4
  v_cvt_f32_u32 v6, v5
  v_cmp_gt_u32 vcc, 128, v5
  v_cvt_pk_bf16_f32 v6, v6, v6
  v_and_b32 v6, 0xffff, v6
  v_subrev_u32 v6, 0x4280, v6
  v_cndmask_b32 v6, v6, v5, vcc
  v_lshlrev_b32 v6, 1, v6
  v_add_u32 v127, 161024, v6
  v_add_u32 v5, 5, v4
  v_cvt_f32_u32 v6, v5
  v_cmp_gt_u32 vcc, 128, v5
  v_cvt_pk_bf16_f32 v6, v6, v6
  v_and_b32 v6, 0xffff, v6
  v_subrev_u32 v6, 0x4280, v6
  v_cndmask_b32 v6, v6, v5, vcc
  v_lshlrev_b32 v6, 1, v6
  v_add_u32 v242, 161024, v6
  v_add_u32 v5, 6, v4
  v_cvt_f32_u32 v6, v5
  v_cmp_gt_u32 vcc, 128, v5
  v_cvt_pk_bf16_f32 v6, v6, v6
  v_and_b32 v6, 0xffff, v6
  v_subrev_u32 v6, 0x4280, v6
  v_cndmask_b32 v6, v6, v5, vcc
  v_lshlrev_b32 v6, 1, v6
  v_add_u32 v243, 161024, v6
  v_add_u32 v5, 7, v4
  v_cvt_f32_u32 v6, v5
  v_cmp_gt_u32 vcc, 128, v5
  v_cvt_pk_bf16_f32 v6, v6, v6
  v_and_b32 v6, 0xffff, v6
  v_subrev_u32 v6, 0x4280, v6
  v_cndmask_b32 v6, v6, v5, vcc
  v_lshlrev_b32 v6, 1, v6
  v_add_u32 v248, 161024, v6
  s_waitcnt vmcnt(0) lgkmcnt(0)
  v_add_u32 v254, 1, v254
  s_nop 0
  v_readfirstlane_b32 s63, v254
  s_barrier
  s_barrier
  s_barrier
  s_barrier
  s_barrier
  s_barrier
  s_barrier
  s_barrier
  s_sub_u32 s48, s3, 4
  v_lshlrev_b32 v44, 4, v1
  s_mov_b32 s44, 12697600
  buffer_load_dwordx4 v[40:43], v44, s[16:19], s44 offen sc1
  s_mov_b32 s28, s84
  s_and_b32 s29, s85, 0xffff
  s_mov_b32 s30, 1409024
  s_mov_b32 s31, 0x20000
  v_lshrrev_b32 v2, 3, v1
  v_and_b32 v3, 7, v1
  v_lshrrev_b32 v4, 1, v2
  v_and_b32 v4, 1, v4
  v_lshlrev_b32 v4, 2, v4
  v_xor_b32 v3, v3, v4
  v_lshlrev_b32 v3, 4, v3
  v_lshlrev_b32 v2, 10, v2
  v_add_u32 v240, v2, v3
  s_mov_b32 s55, s48
  s_mul_i32 s49, s48, 22
  s_cmp_eq_u32 s48, 3
  s_cselect_b32 s42, 1, 0
  s_sub_u32 s49, s49, s42
  s_cmp_ge_u32 s48, 2
  s_cselect_b32 s53, 21, 22
  s_mul_i32 s54, s38, 3
  s_and_b32 s42, s37, 3
  s_mul_i32 s42, s42, 5
  s_add_u32 s54, s54, s42
  s_cmp_ge_u32 s54, s53
  s_cselect_b32 s42, s53, 0
  s_sub_u32 s54, s54, s42
  s_cmp_ge_u32 s54, s53
  s_cselect_b32 s42, s53, 0
  s_sub_u32 s54, s54, s42
  s_and_b32 s50, s48, 1
  s_mul_i32 s50, s50, 20480
  s_cmp_ge_u32 s48, 2
  s_cselect_b32 s42, 107264, 0
  s_add_u32 s50, s50, s42
  s_lshl_b32 s51, s38, 7
  s_lshl_b32 s58, s49, 14
  s_add_u32 s58, s58, s51
  s_lshl_b32 s59, s53, 14
  s_add_u32 s59, s59, s58
  s_lshl_b32 s56, s54, 14
  s_add_u32 s56, s56, s58
  s_add_u32 m0, s50, 0
  s_add_u32 s42, s56, 8192
  buffer_load_dwordx4 v240, s[28:31], s56 offen lds
  s_add_u32 m0, s50, 1024
  s_nop 0
  buffer_load_dwordx4 v240, s[28:31], s42 offen lds
  s_add_u32 s56, s56, 16384
  s_cmp_eq_u32 s56, s59
  s_cselect_b32 s56, s58, s56
  s_add_u32 m0, s50, 2048
  s_add_u32 s42, s56, 8192
  buffer_load_dwordx4 v240, s[28:31], s56 offen lds
  s_add_u32 m0, s50, 3072
  s_nop 0
  buffer_load_dwordx4 v240, s[28:31], s42 offen lds
  s_add_u32 s56, s56, 16384
  s_cmp_eq_u32 s56, s59
  s_cselect_b32 s56, s58, s56
  s_add_u32 m0, s50, 4096
  s_add_u32 s42, s56, 8192
  buffer_load_dwordx4 v240, s[28:31], s56 offen lds
  s_add_u32 m0, s50, 5120
  s_nop 0
  buffer_load_dwordx4 v240, s[28:31], s42 offen lds
  s_add_u32 s56, s56, 16384
  s_cmp_eq_u32 s56, s59
  s_cselect_b32 s56, s58, s56
  s_add_u32 m0, s50, 6144
  s_add_u32 s42, s56, 8192
  buffer_load_dwordx4 v240, s[28:31], s56 offen lds
  s_add_u32 m0, s50, 7168
  s_nop 0
  buffer_load_dwordx4 v240, s[28:31], s42 offen lds
  s_add_u32 s56, s56, 16384
  s_cmp_eq_u32 s56, s59
  s_cselect_b32 s56, s58, s56
  s_add_u32 m0, s50, 8192
  s_add_u32 s42, s56, 8192
  buffer_load_dwordx4 v240, s[28:31], s56 offen lds
  s_add_u32 m0, s50, 9216
  s_nop 0
  buffer_load_dwordx4 v240, s[28:31], s42 offen lds
  s_add_u32 s56, s56, 16384
  s_cmp_eq_u32 s56, s59
  s_cselect_b32 s56, s58, s56
  s_add_u32 m0, s50, 10240
  s_add_u32 s42, s56, 8192
  buffer_load_dwordx4 v240, s[28:31], s56 offen lds
  s_add_u32 m0, s50, 11264
  s_nop 0
  buffer_load_dwordx4 v240, s[28:31], s42 offen lds
  s_add_u32 s56, s56, 16384
  s_cmp_eq_u32 s56, s59
  s_cselect_b32 s56, s58, s56
  s_add_u32 m0, s50, 12288
  s_add_u32 s42, s56, 8192
  buffer_load_dwordx4 v240, s[28:31], s56 offen lds
  s_add_u32 m0, s50, 13312
  s_nop 0
  buffer_load_dwordx4 v240, s[28:31], s42 offen lds
  s_add_u32 s56, s56, 16384
  s_cmp_eq_u32 s56, s59
  s_cselect_b32 s56, s58, s56
  s_add_u32 m0, s50, 14336
  s_add_u32 s42, s56, 8192
  buffer_load_dwordx4 v240, s[28:31], s56 offen lds
  s_add_u32 m0, s50, 15360
  s_nop 0
  buffer_load_dwordx4 v240, s[28:31], s42 offen lds
  s_add_u32 s56, s56, 16384
  s_cmp_eq_u32 s56, s59
  s_cselect_b32 s56, s58, s56
  s_add_u32 m0, s50, 16384
  s_add_u32 s42, s56, 8192
  buffer_load_dwordx4 v240, s[28:31], s56 offen lds
  s_add_u32 m0, s50, 17408
  s_nop 0
  buffer_load_dwordx4 v240, s[28:31], s42 offen lds
  s_add_u32 s56, s56, 16384
  s_cmp_eq_u32 s56, s59
  s_cselect_b32 s56, s58, s56
  s_add_u32 m0, s50, 18432
  s_add_u32 s42, s56, 8192
  buffer_load_dwordx4 v240, s[28:31], s56 offen lds
  s_add_u32 m0, s50, 19456
  s_nop 0
  buffer_load_dwordx4 v240, s[28:31], s42 offen lds
  s_add_u32 s56, s56, 16384
  s_cmp_eq_u32 s56, s59
  s_cselect_b32 s56, s58, s56
  s_mov_b32 s48, s55
  s_barrier
  s_barrier
  s_waitcnt vmcnt(20)
  s_mov_b32 s57, 0
  s_mov_b32 s44, 12697600
L_GP_9:
  v_cmp_ne_u32 vcc, s63, v40
  v_cmp_ne_u32 s[40:41], s63, v41
  s_or_b64 vcc, vcc, s[40:41]
  v_cmp_ne_u32 s[40:41], s63, v42
  s_or_b64 vcc, vcc, s[40:41]
  v_cmp_ne_u32 s[40:41], s63, v43
  s_or_b64 vcc, vcc, s[40:41]
  s_add_u32 s57, s57, 1
  s_cmp_eq_u64 vcc, 0
  s_cbranch_scc1 L_GPD_10
  s_cmp_gt_u32 s57, 100000
  s_cbranch_scc1 L_GPD_10
  s_sleep 8
  buffer_load_dwordx4 v[40:43], v44, s[16:19], s44 offen sc1
  s_waitcnt vmcnt(0)
  s_branch L_GP_9
L_GPD_10:
  v_lshrrev_b32 v2, 1, v1
  v_lshlrev_b32 v2, 13, v2
  v_and_b32 v3, 1, v1
  v_lshlrev_b32 v3, 4, v3
  v_add_u32 v2, v2, v3
  s_lshl_b32 s40, s48, 20
  s_lshl_b32 s41, s36, 5
  s_add_u32 s40, s40, s41
  s_add_u32 s40, s40, 0
  buffer_load_dwordx4 v[8:11], v2, s[16:19], s40 offen sc1
  s_add_u32 s40, s40, 262144
  buffer_load_dwordx4 v[12:15], v2, s[16:19], s40 offen sc1
  s_add_u32 s40, s40, 262144
  buffer_load_dwordx4 v[16:19], v2, s[16:19], s40 offen sc1
  s_add_u32 s40, s40, 262144
  buffer_load_dwordx4 v[20:23], v2, s[16:19], s40 offen sc1
  s_lshl_b32 s40, s37, 9
  s_add_u32 s40, s40, 12582912
  v_lshlrev_b32 v3, 3, v1
  buffer_load_dwordx2 v[232:233], v3, s[16:19], s40 offen sc1
  v_lshrrev_b32 v2, 1, v1
  v_lshlrev_b32 v2, 4, v2
  v_and_b32 v3, 1, v1
  v_mul_u32_u24 v3, 4608, v3
  v_add_u32 v2, v2, v3
  s_lshl_b32 s40, s48, 11
  s_add_u32 s40, s40, 148736
  v_add_u32 v2, s40, v2
  s_mul_i32 s41, s48, 4608
  s_add_u32 s41, s41, 148224
  v_lshlrev_b32 v3, 4, v1
  v_add_u32 v3, s41, v3
  v_mov_b32 v24, 0
  v_mov_b32 v25, 0
  v_mov_b32 v26, 0
  v_mov_b32 v27, 0
  s_mov_b32 exec_lo, -1
  s_mov_b32 exec_hi, 0
  ds_write_b128 v3, v[24:27]
  s_mov_b64 exec, -1
  s_waitcnt vmcnt(0)
  ds_write_b128 v2, v[8:11] offset:0
  ds_write_b128 v2, v[12:15] offset:512
  ds_write_b128 v2, v[16:19] offset:1024
  ds_write_b128 v2, v[20:23] offset:1536
  s_waitcnt lgkmcnt(0)
  s_lshl_b32 s40, s48, 2
  s_add_u32 s40, s40, 160944
  v_mov_b32 v2, s40
  v_mov_b32 v3, 1
  ds_write_b32 v2, v3
  s_branch L_POST1
L_W45G:
  s_setprio 3
  s_sub_u32 s48, s3, 4
  s_lshl_b32 s46, s32, 17
  s_lshl_b32 s42, s48, 16
  s_add_u32 s46, s46, s42
  s_mul_i32 s47, s48, 88064
  s_mul_i32 s42, s33, 192
  s_add_u32 s47, s47, s42
  s_mov_b32 s50, 1
  s_mov_b32 s53, 49152
  s_add_u32 s40, s34, s50
  s_and_b32 s40, s40, 7
  s_lshl_b32 s42, s40, 7
  s_add_u32 s41, s46, s42
  s_mul_i32 s42, s40, 176128
  s_add_u32 s42, s42, s47
  s_lshl_b32 s43, s48, 13
  s_add_u32 s43, s43, s53
  s_add_u32 m0, s43, 0
  s_nop 0
  buffer_load_dwordx4 v200, s[4:7], s41 offen lds
  s_add_u32 m0, s43, 1024
  s_add_u32 s41, s41, 8192
  buffer_load_dwordx4 v201, s[4:7], s41 offen lds
  s_add_u32 m0, s43, 2048
  s_add_u32 s41, s41, 8192
  buffer_load_dwordx4 v200, s[4:7], s41 offen lds
  s_add_u32 m0, s43, 3072
  s_add_u32 s41, s41, 8192
  buffer_load_dwordx4 v201, s[4:7], s41 offen lds
  s_add_u32 m0, s43, 4096
  s_add_u32 s41, s41, 8192
  buffer_load_dwordx4 v200, s[4:7], s41 offen lds
  s_add_u32 m0, s43, 5120
  s_add_u32 s41, s41, 8192
  buffer_load_dwordx4 v201, s[4:7], s41 offen lds
  s_add_u32 m0, s43, 6144
  s_add_u32 s41, s41, 8192
  buffer_load_dwordx4 v200, s[4:7], s41 offen lds
  s_add_u32 m0, s43, 7168
  s_add_u32 s41, s41, 8192
  buffer_load_dwordx4 v201, s[4:7], s41 offen lds
  s_add_u32 m0, s43, 16384
  s_nop 0
  buffer_load_dwordx4 v202, s[8:11], s42 offen lds
  s_add_u32 m0, s43, 32768
  s_nop 0
  buffer_load_dwordx4 v203, s[12:15], s42 offen lds
  s_add_u32 m0, s43, 17408
  s_add_u32 s42, s42, 11008
  buffer_load_dwordx4 v202, s[8:11], s42 offen lds
  s_add_u32 m0, s43, 33792
  s_nop 0
  buffer_load_dwordx4 v203, s[12:15], s42 offen lds
  s_add_u32 m0, s43, 18432
  s_add_u32 s42, s42, 11008
  buffer_load_dwordx4 v202, s[8:11], s42 offen lds
  s_add_u32 m0, s43, 34816
  s_nop 0
  buffer_load_dwordx4 v203, s[12:15], s42 offen lds
  s_add_u32 m0, s43, 19456
  s_add_u32 s42, s42, 11008
  buffer_load_dwordx4 v202, s[8:11], s42 offen lds
  s_add_u32 m0, s43, 35840
  s_nop 0
  buffer_load_dwordx4 v203, s[12:15], s42 offen lds
  s_add_u32 m0, s43, 20480
  s_add_u32 s42, s42, 11008
  buffer_load_dwordx4 v202, s[8:11], s42 offen lds
  s_add_u32 m0, s43, 36864
  s_nop 0
  buffer_load_dwordx4 v203, s[12:15], s42 offen lds
  s_add_u32 m0, s43, 21504
  s_add_u32 s42, s42, 11008
  buffer_load_dwordx4 v202, s[8:11], s42 offen lds
  s_add_u32 m0, s43, 37888
  s_nop 0
  buffer_load_dwordx4 v203, s[12:15], s42 offen lds
  s_add_u32 m0, s43, 22528
  s_add_u32 s42, s42, 11008
  buffer_load_dwordx4 v202, s[8:11], s42 offen lds
  s_add_u32 m0, s43, 38912
  s_nop 0
  buffer_load_dwordx4 v203, s[12:15], s42 offen lds
  s_add_u32 m0, s43, 23552
  s_add_u32 s42, s42, 11008
  buffer_load_dwordx4 v202, s[8:11], s42 offen lds
  s_add_u32 m0, s43, 39936
  s_nop 0
  buffer_load_dwordx4 v203, s[12:15], s42 offen lds
  v_and_b32 v4, 255, v0
  v_lshlrev_b32 v4, 3, v4
  v_subrev_u32 v5, 3, v4
  v_cvt_f32_u32 v6, v5
  v_cmp_gt_u32 vcc, 128, v5
  v_cvt_pk_bf16_f32 v6, v6, v6
  v_and_b32 v6, 0xffff, v6
  v_subrev_u32 v6, 0x4280, v6
  v_cndmask_b32 v6, v6, v5, vcc
  v_cmp_gt_i32 vcc, 0, v5
  v_mov_b32 v7, 661
  s_nop 0
  v_cndmask_b32 v6, v6, v7, vcc
  v_lshlrev_b32 v6, 1, v6
  v_add_u32 v120, 161024, v6
  v_subrev_u32 v5, 2, v4
  v_cvt_f32_u32 v6, v5
  v_cmp_gt_u32 vcc, 128, v5
  v_cvt_pk_bf16_f32 v6, v6, v6
  v_and_b32 v6, 0xffff, v6
  v_subrev_u32 v6, 0x4280, v6
  v_cndmask_b32 v6, v6, v5, vcc
  v_cmp_gt_i32 vcc, 0, v5
  v_mov_b32 v7, 661
  s_nop 0
  v_cndmask_b32 v6, v6, v7, vcc
  v_lshlrev_b32 v6, 1, v6
  v_add_u32 v121, 161024, v6
  v_subrev_u32 v5, 1, v4
  v_cvt_f32_u32 v6, v5
  v_cmp_gt_u32 vcc, 128, v5
  v_cvt_pk_bf16_f32 v6, v6, v6
  v_and_b32 v6, 0xffff, v6
  v_subrev_u32 v6, 0x4280, v6
  v_cndmask_b32 v6, v6, v5, vcc
  v_cmp_gt_i32 vcc, 0, v5
  v_mov_b32 v7, 661
  s_nop 0
  v_cndmask_b32 v6, v6, v7, vcc
  v_lshlrev_b32 v6, 1, v6
  v_add_u32 v122, 161024, v6
  v_add_u32 v5, 0, v4
  v_cvt_f32_u32 v6, v5
  v_cmp_gt_u32 vcc, 128, v5
  v_cvt_pk_bf16_f32 v6, v6, v6
  v_and_b32 v6, 0xffff, v6
  v_subrev_u32 v6, 0x4280, v6
  v_cndmask_b32 v6, v6, v5, vcc
  v_lshlrev_b32 v6, 1, v6
  v_add_u32 v123, 161024, v6
  v_add_u32 v5, 1, v4
  v_cvt_f32_u32 v6, v5
  v_cmp_gt_u32 vcc, 128, v5
  v_cvt_pk_bf16_f32 v6, v6, v6
  v_and_b32 v6, 0xffff, v6
  v_subrev_u32 v6, 0x4280, v6
  v_cndmask_b32 v6, v6, v5, vcc
  v_lshlrev_b32 v6, 1, v6
  v_add_u32 v124, 161024, v6
  v_add_u32 v5, 2, v4
  v_cvt_f32_u32 v6, v5
  v_cmp_gt_u32 vcc, 128, v5
  v_cvt_pk_bf16_f32 v6, v6, v6
  v_and_b32 v6, 0xffff, v6
  v_subrev_u32 v6, 0x4280, v6
  v_cndmask_b32 v6, v6, v5, vcc
  v_lshlrev_b32 v6, 1, v6
  v_add_u32 v125, 161024, v6
  v_add_u32 v5, 3, v4
  v_cvt_f32_u32 v6, v5
  v_cmp_gt_u32 vcc, 128, v5
  v_cvt_pk_bf16_f32 v6, v6, v6
  v_and_b32 v6, 0xffff, v6
  v_subrev_u32 v6, 0x4280, v6
  v_cndmask_b32 v6, v6, v5, vcc
  v_lshlrev_b32 v6, 1, v6
  v_add_u32 v126, 161024, v6
  v_add_u32 v5, 4, v4
  v_cvt_f32_u32 v6, v5
  v_cmp_gt_u32 vcc, 128, v5
  v_cvt_pk_bf16_f32 v6, v6, v6
  v_and_b32 v6, 0xffff, v6
  v_subrev_u32 v6, 0x4280, v6
  v_cndmask_b32 v6, v6, v5, vcc
  v_lshlrev_b32 v6, 1, v6
  v_add_u32 v127, 161024, v6
  v_add_u32 v5, 5, v4
  v_cvt_f32_u32 v6, v5
  v_cmp_gt_u32 vcc, 128, v5
  v_cvt_pk_bf16_f32 v6, v6, v6
  v_and_b32 v6, 0xffff, v6
  v_subrev_u32 v6, 0x4280, v6
  v_cndmask_b32 v6, v6, v5, vcc
  v_lshlrev_b32 v6, 1, v6
  v_add_u32 v242, 161024, v6
  v_add_u32 v5, 6, v4
  v_cvt_f32_u32 v6, v5
  v_cmp_gt_u32 vcc, 128, v5
  v_cvt_pk_bf16_f32 v6, v6, v6
  v_and_b32 v6, 0xffff, v6
  v_subrev_u32 v6, 0x4280, v6
  v_cndmask_b32 v6, v6, v5, vcc
  v_lshlrev_b32 v6, 1, v6
  v_add_u32 v243, 161024, v6
  v_add_u32 v5, 7, v4
  v_cvt_f32_u32 v6, v5
  v_cmp_gt_u32 vcc, 128, v5
  v_cvt_pk_bf16_f32 v6, v6, v6
  v_and_b32 v6, 0xffff, v6
  v_subrev_u32 v6, 0x4280, v6
  v_cndmask_b32 v6, v6, v5, vcc
  v_lshlrev_b32 v6, 1, v6
  v_add_u32 v248, 161024, v6
  s_waitcnt vmcnt(24)
  v_add_u32 v254, 1, v254
  s_nop 0
  v_readfirstlane_b32 s63, v254
  s_barrier
  s_mov_b32 s50, 2
  s_mov_b32 s53, 98304
L_DMA_LOOP:
  s_add_u32 s40, s34, s50
  s_and_b32 s40, s40, 7
  s_lshl_b32 s42, s40, 7
  s_add_u32 s41, s46, s42
  s_mul_i32 s42, s40, 176128
  s_add_u32 s42, s42, s47
  s_lshl_b32 s43, s48, 13
  s_add_u32 s43, s43, s53
  s_add_u32 m0, s43, 0
  s_nop 0
  buffer_load_dwordx4 v200, s[4:7], s41 offen lds
  s_add_u32 m0, s43, 1024
  s_add_u32 s41, s41, 8192
  buffer_load_dwordx4 v201, s[4:7], s41 offen lds
  s_add_u32 m0, s43, 2048
  s_add_u32 s41, s41, 8192
  buffer_load_dwordx4 v200, s[4:7], s41 offen lds
  s_add_u32 m0, s43, 3072
  s_add_u32 s41, s41, 8192
  buffer_load_dwordx4 v201, s[4:7], s41 offen lds
  s_add_u32 m0, s43, 4096
  s_add_u32 s41, s41, 8192
  buffer_load_dwordx4 v200, s[4:7], s41 offen lds
  s_add_u32 m0, s43, 5120
  s_add_u32 s41, s41, 8192
  buffer_load_dwordx4 v201, s[4:7], s41 offen lds
  s_add_u32 m0, s43, 6144
  s_add_u32 s41, s41, 8192
  buffer_load_dwordx4 v200, s[4:7], s41 offen lds
  s_add_u32 m0, s43, 7168
  s_add_u32 s41, s41, 8192
  buffer_load_dwordx4 v201, s[4:7], s41 offen lds
  s_add_u32 m0, s43, 16384
  s_nop 0
  buffer_load_dwordx4 v202, s[8:11], s42 offen lds
  s_add_u32 m0, s43, 32768
  s_nop 0
  buffer_load_dwordx4 v203, s[12:15], s42 offen lds
  s_add_u32 m0, s43, 17408
  s_add_u32 s42, s42, 11008
  buffer_load_dwordx4 v202, s[8:11], s42 offen lds
  s_add_u32 m0, s43, 33792
  s_nop 0
  buffer_load_dwordx4 v203, s[12:15], s42 offen lds
  s_add_u32 m0, s43, 18432
  s_add_u32 s42, s42, 11008
  buffer_load_dwordx4 v202, s[8:11], s42 offen lds
  s_add_u32 m0, s43, 34816
  s_nop 0
  buffer_load_dwordx4 v203, s[12:15], s42 offen lds
  s_add_u32 m0, s43, 19456
  s_add_u32 s42, s42, 11008
  buffer_load_dwordx4 v202, s[8:11], s42 offen lds
  s_add_u32 m0, s43, 35840
  s_nop 0
  buffer_load_dwordx4 v203, s[12:15], s42 offen lds
  s_add_u32 m0, s43, 20480
  s_add_u32 s42, s42, 11008
  buffer_load_dwordx4 v202, s[8:11], s42 offen lds
  s_add_u32 m0, s43, 36864
  s_nop 0
  buffer_load_dwordx4 v203, s[12:15], s42 offen lds
  s_add_u32 m0, s43, 21504
  s_add_u32 s42, s42, 11008
  buffer_load_dwordx4 v202, s[8:11], s42 offen lds
  s_add_u32 m0, s43, 37888
  s_nop 0
  buffer_load_dwordx4 v203, s[12:15], s42 offen lds
  s_add_u32 m0, s43, 22528
  s_add_u32 s42, s42, 11008
  buffer_load_dwordx4 v202, s[8:11], s42 offen lds
  s_add_u32 m0, s43, 38912
  s_nop 0
  buffer_load_dwordx4 v203, s[12:15], s42 offen lds
  s_add_u32 m0, s43, 23552
  s_add_u32 s42, s42, 11008
  buffer_load_dwordx4 v202, s[8:11], s42 offen lds
  s_add_u32 m0, s43, 39936
  s_nop 0
  buffer_load_dwordx4 v203, s[12:15], s42 offen lds
  s_waitcnt vmcnt(24)
  s_barrier
L_DMA_NEXT:
  s_add_u32 s50, s50, 1
  s_add_u32 s53, s53, 49152
  s_cmp_eq_u32 s53, 147456
  s_cselect_b32 s53, 0, s53
  s_cmp_lt_u32 s50, 7
  s_cbranch_scc1 L_DMA_LOOP
  v_mov_b32 v38, 0
  s_cmp_eq_u32 s48, 0
  s_cbranch_scc0 L_D4_11
  s_lshl_b32 s40, s32, 7
  s_add_u32 s40, s40, 12681216
  s_lshl_b32 s41, s33, 1
  s_lshr_b32 s42, s32, 3
  s_add_u32 s41, s41, s42
  s_lshl_b32 s41, s41, 7
  s_add_u32 s41, s41, 12683136
  v_min_u32 v3, 39, v1
  v_lshlrev_b32 v3, 2, v3
  v_cmp_gt_u32 vcc, 32, v1
  v_mov_b32 v38, s41
  v_mov_b32 v4, s40
  s_nop 0
  v_cndmask_b32 v38, v38, v4, vcc
  v_add_u32 v38, v38, v3
  buffer_load_dword v39, v38, s[16:19], 0 offen sc1
L_D4_11:
  s_add_u32 s40, s34, s50
  s_and_b32 s40, s40, 7
  s_lshl_b32 s42, s40, 7
  s_add_u32 s41, s46, s42
  s_mul_i32 s42, s40, 176128
  s_add_u32 s42, s42, s47
  s_lshl_b32 s43, s48, 13
  s_add_u32 s43, s43, s53
  s_add_u32 m0, s43, 0
  s_nop 0
  buffer_load_dwordx4 v200, s[4:7], s41 offen lds
  s_add_u32 m0, s43, 1024
  s_add_u32 s41, s41, 8192
  buffer_load_dwordx4 v201, s[4:7], s41 offen lds
  s_add_u32 m0, s43, 2048
  s_add_u32 s41, s41, 8192
  buffer_load_dwordx4 v200, s[4:7], s41 offen lds
  s_add_u32 m0, s43, 3072
  s_add_u32 s41, s41, 8192
  buffer_load_dwordx4 v201, s[4:7], s41 offen lds
  s_add_u32 m0, s43, 4096
  s_add_u32 s41, s41, 8192
  buffer_load_dwordx4 v200, s[4:7], s41 offen lds
  s_add_u32 m0, s43, 5120
  s_add_u32 s41, s41, 8192
  buffer_load_dwordx4 v201, s[4:7], s41 offen lds
  s_add_u32 m0, s43, 6144
  s_add_u32 s41, s41, 8192
  buffer_load_dwordx4 v200, s[4:7], s41 offen lds
  s_add_u32 m0, s43, 7168
  s_add_u32 s41, s41, 8192
  buffer_load_dwordx4 v201, s[4:7], s41 offen lds
  s_add_u32 m0, s43, 16384
  s_nop 0
  buffer_load_dwordx4 v202, s[8:11], s42 offen lds
  s_add_u32 m0, s43, 32768
  s_nop 0
  buffer_load_dwordx4 v203, s[12:15], s42 offen lds
  s_add_u32 m0, s43, 17408
  s_add_u32 s42, s42, 11008
  buffer_load_dwordx4 v202, s[8:11], s42 offen lds
  s_add_u32 m0, s43, 33792
  s_nop 0
  buffer_load_dwordx4 v203, s[12:15], s42 offen lds
  s_add_u32 m0, s43, 18432
  s_add_u32 s42, s42, 11008
  buffer_load_dwordx4 v202, s[8:11], s42 offen lds
  s_add_u32 m0, s43, 34816
  s_nop 0
  buffer_load_dwordx4 v203, s[12:15], s42 offen lds
  s_add_u32 m0, s43, 19456
  s_add_u32 s42, s42, 11008
  buffer_load_dwordx4 v202, s[8:11], s42 offen lds
  s_add_u32 m0, s43, 35840
  s_nop 0
  buffer_load_dwordx4 v203, s[12:15], s42 offen lds
  s_add_u32 m0, s43, 20480
  s_add_u32 s42, s42, 11008
  buffer_load_dwordx4 v202, s[8:11], s42 offen lds
  s_add_u32 m0, s43, 36864
  s_nop 0
  buffer_load_dwordx4 v203, s[12:15], s42 offen lds
  s_add_u32 m0, s43, 21504
  s_add_u32 s42, s42, 11008
  buffer_load_dwordx4 v202, s[8:11], s42 offen lds
  s_add_u32 m0, s43, 37888
  s_nop 0
  buffer_load_dwordx4 v203, s[12:15], s42 offen lds
  s_add_u32 m0, s43, 22528
  s_add_u32 s42, s42, 11008
  buffer_load_dwordx4 v202, s[8:11], s42 offen lds
  s_add_u32 m0, s43, 38912
  s_nop 0
  buffer_load_dwordx4 v203, s[12:15], s42 offen lds
  s_add_u32 m0, s43, 23552
  s_add_u32 s42, s42, 11008
  buffer_load_dwordx4 v202, s[8:11], s42 offen lds
  s_add_u32 m0, s43, 39936
  s_nop 0
  buffer_load_dwordx4 v203, s[12:15], s42 offen lds
  s_waitcnt vmcnt(24)
  s_barrier
  s_cmp_eq_u32 s48, 0
  s_cbranch_scc0 L_D4B_12
  s_mov_b32 s57, 0
L_EIP_13:
  v_cmp_ne_u32 vcc, s63, v39
  s_add_u32 s57, s57, 1
  s_cmp_eq_u64 vcc, 0
  s_cbranch_scc1 L_EIPD_14
  s_cmp_gt_u32 s57, 100000
  s_cbranch_scc1 L_EIPD_14
  s_sleep 4
  buffer_load_dword v39, v38, s[16:19], 0 offen sc1
  s_waitcnt vmcnt(0)
  s_branch L_EIP_13
L_EIPD_14:
  s_lshl_b32 s44, s32, 10
  s_add_u32 s44, s44, 12582912
  v_lshlrev_b32 v2, 4, v1
  buffer_load_dwordx4 v[4:7], v2, s[16:19], s44 offen sc1
  s_lshl_b32 s40, s33, 1
  s_lshr_b32 s41, s32, 3
  s_add_u32 s40, s40, s41
  s_mul_i32 s40, s40, 6144
  s_add_u32 s40, s40, 12713984
  s_add_u32 s45, s40, 3072
  s_mov_b32 exec_lo, -1
  s_mov_b32 exec_hi, 0xffff
  buffer_load_dwordx4 v[8:11], v2, s[16:19], s40 offen offset:0 sc1
  buffer_load_dwordx4 v[12:15], v2, s[16:19], s40 offen offset:768 sc1
  buffer_load_dwordx4 v[16:19], v2, s[16:19], s40 offen offset:1536 sc1
  buffer_load_dwordx4 v[20:23], v2, s[16:19], s40 offen offset:2304 sc1
  buffer_load_dwordx4 v[24:27], v2, s[16:19], s45 offen offset:0 sc1
  buffer_load_dwordx4 v[28:31], v2, s[16:19], s45 offen offset:768 sc1
  buffer_load_dwordx4 v[32:35], v2, s[16:19], s45 offen offset:1536 sc1
  buffer_load_dwordx4 v[36:39], v2, s[16:19], s45 offen offset:2304 sc1
  s_mov_b64 exec, -1
  s_waitcnt vmcnt(9)
  s_barrier
  s_waitcnt vmcnt(0)
  v_lshlrev_b32 v2, 4, v1
  v_add_u32 v3, 157568, v2
  ds_write_b128 v3, v[4:7]
  v_add_f32 v8, v8, v12
  v_add_f32 v9, v9, v13
  v_add_f32 v10, v10, v14
  v_add_f32 v11, v11, v15
  v_add_f32 v8, v8, v16
  v_add_f32 v9, v9, v17
  v_add_f32 v10, v10, v18
  v_add_f32 v11, v11, v19
  v_add_f32 v8, v8, v20
  v_add_f32 v9, v9, v21
  v_add_f32 v10, v10, v22
  v_add_f32 v11, v11, v23
  v_add_f32 v8, v8, v24
  v_add_f32 v9, v9, v25
  v_add_f32 v10, v10, v26
  v_add_f32 v11, v11, v27
  v_add_f32 v8, v8, v28
  v_add_f32 v9, v9, v29
  v_add_f32 v10, v10, v30
  v_add_f32 v11, v11, v31
  v_add_f32 v8, v8, v32
  v_add_f32 v9, v9, v33
  v_add_f32 v10, v10, v34
  v_add_f32 v11, v11, v35
  v_add_f32 v8, v8, v36
  v_add_f32 v9, v9, v37
  v_add_f32 v10, v10, v38
  v_add_f32 v11, v11, v39
  v_add_u32 v3, 160128, v2
  s_mov_b32 exec_lo, -1
  s_mov_b32 exec_hi, 0xffff
  ds_write_b128 v3, v[8:11]
  s_mov_b64 exec, -1
  s_waitcnt lgkmcnt(0)
  s_branch L_D5_15
L_D4B_12:
  s_waitcnt vmcnt(0)
  s_barrier
L_D5_15:
  v_lshlrev_b32 v44, 4, v1
  s_mov_b32 s44, 12697600
  buffer_load_dwordx4 v[40:43], v44, s[16:19], s44 offen sc1
  s_mov_b32 s28, s84
  s_and_b32 s29, s85, 0xffff
  s_mov_b32 s30, 1409024
  s_mov_b32 s31, 0x20000
  v_lshrrev_b32 v2, 3, v1
  v_and_b32 v3, 7, v1
  v_lshrrev_b32 v4, 1, v2
  v_and_b32 v4, 1, v4
  v_lshlrev_b32 v4, 2, v4
  v_xor_b32 v3, v3, v4
  v_lshlrev_b32 v3, 4, v3
  v_lshlrev_b32 v2, 10, v2
  v_add_u32 v240, v2, v3
  s_mov_b32 s55, s48
  s_mul_i32 s49, s48, 22
  s_cmp_eq_u32 s48, 3
  s_cselect_b32 s42, 1, 0
  s_sub_u32 s49, s49, s42
  s_cmp_ge_u32 s48, 2
  s_cselect_b32 s53, 21, 22
  s_mul_i32 s54, s38, 3
  s_and_b32 s42, s37, 3
  s_mul_i32 s42, s42, 5
  s_add_u32 s54, s54, s42
  s_cmp_ge_u32 s54, s53
  s_cselect_b32 s42, s53, 0
  s_sub_u32 s54, s54, s42
  s_cmp_ge_u32 s54, s53
  s_cselect_b32 s42, s53, 0
  s_sub_u32 s54, s54, s42
  s_and_b32 s50, s48, 1
  s_mul_i32 s50, s50, 20480
  s_cmp_ge_u32 s48, 2
  s_cselect_b32 s42, 107264, 0
  s_add_u32 s50, s50, s42
  s_lshl_b32 s51, s38, 7
  s_lshl_b32 s58, s49, 14
  s_add_u32 s58, s58, s51
  s_lshl_b32 s59, s53, 14
  s_add_u32 s59, s59, s58
  s_lshl_b32 s56, s54, 14
  s_add_u32 s56, s56, s58
  s_add_u32 m0, s50, 0
  s_add_u32 s42, s56, 8192
  buffer_load_dwordx4 v240, s[28:31], s56 offen lds
  s_add_u32 m0, s50, 1024
  s_nop 0
  buffer_load_dwordx4 v240, s[28:31], s42 offen lds
  s_add_u32 s56, s56, 16384
  s_cmp_eq_u32 s56, s59
  s_cselect_b32 s56, s58, s56
  s_add_u32 m0, s50, 2048
  s_add_u32 s42, s56, 8192
  buffer_load_dwordx4 v240, s[28:31], s56 offen lds
  s_add_u32 m0, s50, 3072
  s_nop 0
  buffer_load_dwordx4 v240, s[28:31], s42 offen lds
  s_add_u32 s56, s56, 16384
  s_cmp_eq_u32 s56, s59
  s_cselect_b32 s56, s58, s56
  s_add_u32 m0, s50, 4096
  s_add_u32 s42, s56, 8192
  buffer_load_dwordx4 v240, s[28:31], s56 offen lds
  s_add_u32 m0, s50, 5120
  s_nop 0
  buffer_load_dwordx4 v240, s[28:31], s42 offen lds
  s_add_u32 s56, s56, 16384
  s_cmp_eq_u32 s56, s59
  s_cselect_b32 s56, s58, s56
  s_add_u32 m0, s50, 6144
  s_add_u32 s42, s56, 8192
  buffer_load_dwordx4 v240, s[28:31], s56 offen lds
  s_add_u32 m0, s50, 7168
  s_nop 0
  buffer_load_dwordx4 v240, s[28:31], s42 offen lds
  s_add_u32 s56, s56, 16384
  s_cmp_eq_u32 s56, s59
  s_cselect_b32 s56, s58, s56
  s_add_u32 m0, s50, 8192
  s_add_u32 s42, s56, 8192
  buffer_load_dwordx4 v240, s[28:31], s56 offen lds
  s_add_u32 m0, s50, 9216
  s_nop 0
  buffer_load_dwordx4 v240, s[28:31], s42 offen lds
  s_add_u32 s56, s56, 16384
  s_cmp_eq_u32 s56, s59
  s_cselect_b32 s56, s58, s56
  s_add_u32 m0, s50, 10240
  s_add_u32 s42, s56, 8192
  buffer_load_dwordx4 v240, s[28:31], s56 offen lds
  s_add_u32 m0, s50, 11264
  s_nop 0
  buffer_load_dwordx4 v240, s[28:31], s42 offen lds
  s_add_u32 s56, s56, 16384
  s_cmp_eq_u32 s56, s59
  s_cselect_b32 s56, s58, s56
  s_add_u32 m0, s50, 12288
  s_add_u32 s42, s56, 8192
  buffer_load_dwordx4 v240, s[28:31], s56 offen lds
  s_add_u32 m0, s50, 13312
  s_nop 0
  buffer_load_dwordx4 v240, s[28:31], s42 offen lds
  s_add_u32 s56, s56, 16384
  s_cmp_eq_u32 s56, s59
  s_cselect_b32 s56, s58, s56
  s_add_u32 m0, s50, 14336
  s_add_u32 s42, s56, 8192
  buffer_load_dwordx4 v240, s[28:31], s56 offen lds
  s_add_u32 m0, s50, 15360
  s_nop 0
  buffer_load_dwordx4 v240, s[28:31], s42 offen lds
  s_add_u32 s56, s56, 16384
  s_cmp_eq_u32 s56, s59
  s_cselect_b32 s56, s58, s56
  s_add_u32 m0, s50, 16384
  s_add_u32 s42, s56, 8192
  buffer_load_dwordx4 v240, s[28:31], s56 offen lds
  s_add_u32 m0, s50, 17408
  s_nop 0
  buffer_load_dwordx4 v240, s[28:31], s42 offen lds
  s_add_u32 s56, s56, 16384
  s_cmp_eq_u32 s56, s59
  s_cselect_b32 s56, s58, s56
  s_add_u32 m0, s50, 18432
  s_add_u32 s42, s56, 8192
  buffer_load_dwordx4 v240, s[28:31], s56 offen lds
  s_add_u32 m0, s50, 19456
  s_nop 0
  buffer_load_dwordx4 v240, s[28:31], s42 offen lds
  s_add_u32 s56, s56, 16384
  s_cmp_eq_u32 s56, s59
  s_cselect_b32 s56, s58, s56
  s_mov_b32 s48, s55
  s_barrier
  s_barrier
  s_waitcnt vmcnt(20)
  s_mov_b32 s57, 0
  s_mov_b32 s44, 12697600
L_GP_16:
  v_cmp_ne_u32 vcc, s63, v40
  v_cmp_ne_u32 s[40:41], s63, v41
  s_or_b64 vcc, vcc, s[40:41]
  v_cmp_ne_u32 s[40:41], s63, v42
  s_or_b64 vcc, vcc, s[40:41]
  v_cmp_ne_u32 s[40:41], s63, v43
  s_or_b64 vcc, vcc, s[40:41]
  s_add_u32 s57, s57, 1
  s_cmp_eq_u64 vcc, 0
  s_cbranch_scc1 L_GPD_17
  s_cmp_gt_u32 s57, 100000
  s_cbranch_scc1 L_GPD_17
  s_sleep 8
  buffer_load_dwordx4 v[40:43], v44, s[16:19], s44 offen sc1
  s_waitcnt vmcnt(0)
  s_branch L_GP_16
L_GPD_17:
  v_lshrrev_b32 v2, 1, v1
  v_lshlrev_b32 v2, 13, v2
  v_and_b32 v3, 1, v1
  v_lshlrev_b32 v3, 4, v3
  v_add_u32 v2, v2, v3
  s_lshl_b32 s40, s48, 20
  s_lshl_b32 s41, s36, 5
  s_add_u32 s40, s40, s41
  s_add_u32 s40, s40, 0
  buffer_load_dwordx4 v[8:11], v2, s[16:19], s40 offen sc1
  s_add_u32 s40, s40, 262144
  buffer_load_dwordx4 v[12:15], v2, s[16:19], s40 offen sc1
  s_add_u32 s40, s40, 262144
  buffer_load_dwordx4 v[16:19], v2, s[16:19], s40 offen sc1
  s_add_u32 s40, s40, 262144
  buffer_load_dwordx4 v[20:23], v2, s[16:19], s40 offen sc1
  s_lshl_b32 s40, s37, 9
  s_add_u32 s40, s40, 12582912
  v_lshlrev_b32 v3, 3, v1
  buffer_load_dwordx2 v[232:233], v3, s[16:19], s40 offen sc1
  v_lshrrev_b32 v2, 1, v1
  v_lshlrev_b32 v2, 4, v2
  v_and_b32 v3, 1, v1
  v_mul_u32_u24 v3, 4608, v3
  v_add_u32 v2, v2, v3
  s_lshl_b32 s40, s48, 11
  s_add_u32 s40, s40, 148736
  v_add_u32 v2, s40, v2
  s_mul_i32 s41, s48, 4608
  s_add_u32 s41, s41, 148224
  v_lshlrev_b32 v3, 4, v1
  v_add_u32 v3, s41, v3
  v_mov_b32 v24, 0
  v_mov_b32 v25, 0
  v_mov_b32 v26, 0
  v_mov_b32 v27, 0
  s_mov_b32 exec_lo, -1
  s_mov_b32 exec_hi, 0
  ds_write_b128 v3, v[24:27]
  s_mov_b64 exec, -1
  s_waitcnt vmcnt(0)
  ds_write_b128 v2, v[8:11] offset:0
  ds_write_b128 v2, v[12:15] offset:512
  ds_write_b128 v2, v[16:19] offset:1024
  ds_write_b128 v2, v[20:23] offset:1536
  s_waitcnt lgkmcnt(0)
  s_lshl_b32 s40, s48, 2
  s_add_u32 s40, s40, 160944
  v_mov_b32 v2, s40
  v_mov_b32 v3, 1
  ds_write_b32 v2, v3
  s_branch L_POST1
L_LN:
  s_setprio 0
  s_sub_u32 s48, s3, 6
  v_mov_b32 v2, 160896
  v_lshlrev_b32 v3, 2, v1
  v_add_u32 v2, v2, v3
  v_mov_b32 v3, 0
  s_cmp_eq_u32 s48, 0
  s_cbranch_scc0 L_LN_NOZ
  s_mov_b64 exec, 0xffff
  ds_write_b32 v2, v3
  s_mov_b64 exec, -1
L_LN_NOZ:
  v_and_b32 v4, 255, v0
  v_lshlrev_b32 v4, 3, v4
  v_subrev_u32 v5, 3, v4
  v_cvt_f32_u32 v6, v5
  v_cmp_gt_u32 vcc, 128, v5
  v_cvt_pk_bf16_f32 v6, v6, v6
  v_and_b32 v6, 0xffff, v6
  v_subrev_u32 v6, 0x4280, v6
  v_cndmask_b32 v6, v6, v5, vcc
  v_cmp_gt_i32 vcc, 0, v5
  v_mov_b32 v7, 661
  s_nop 0
  v_cndmask_b32 v6, v6, v7, vcc
  v_lshlrev_b32 v6, 1, v6
  v_add_u32 v120, 161024, v6
  v_subrev_u32 v5, 2, v4
  v_cvt_f32_u32 v6, v5
  v_cmp_gt_u32 vcc, 128, v5
  v_cvt_pk_bf16_f32 v6, v6, v6
  v_and_b32 v6, 0xffff, v6
  v_subrev_u32 v6, 0x4280, v6
  v_cndmask_b32 v6, v6, v5, vcc
  v_cmp_gt_i32 vcc, 0, v5
  v_mov_b32 v7, 661
  s_nop 0
  v_cndmask_b32 v6, v6, v7, vcc
  v_lshlrev_b32 v6, 1, v6
  v_add_u32 v121, 161024, v6
  v_subrev_u32 v5, 1, v4
  v_cvt_f32_u32 v6, v5
  v_cmp_gt_u32 vcc, 128, v5
  v_cvt_pk_bf16_f32 v6, v6, v6
  v_and_b32 v6, 0xffff, v6
  v_subrev_u32 v6, 0x4280, v6
  v_cndmask_b32 v6, v6, v5, vcc
  v_cmp_gt_i32 vcc, 0, v5
  v_mov_b32 v7, 661
  s_nop 0
  v_cndmask_b32 v6, v6, v7, vcc
  v_lshlrev_b32 v6, 1, v6
  v_add_u32 v122, 161024, v6
  v_add_u32 v5, 0, v4
  v_cvt_f32_u32 v6, v5
  v_cmp_gt_u32 vcc, 128, v5
  v_cvt_pk_bf16_f32 v6, v6, v6
  v_and_b32 v6, 0xffff, v6
  v_subrev_u32 v6, 0x4280, v6
  v_cndmask_b32 v6, v6, v5, vcc
  v_lshlrev_b32 v6, 1, v6
  v_add_u32 v123, 161024, v6
  v_add_u32 v5, 1, v4
  v_cvt_f32_u32 v6, v5
  v_cmp_gt_u32 vcc, 128, v5
  v_cvt_pk_bf16_f32 v6, v6, v6
  v_and_b32 v6, 0xffff, v6
  v_subrev_u32 v6, 0x4280, v6
  v_cndmask_b32 v6, v6, v5, vcc
  v_lshlrev_b32 v6, 1, v6
  v_add_u32 v124, 161024, v6
  v_add_u32 v5, 2, v4
  v_cvt_f32_u32 v6, v5
  v_cmp_gt_u32 vcc, 128, v5
  v_cvt_pk_bf16_f32 v6, v6, v6
  v_and_b32 v6, 0xffff, v6
  v_subrev_u32 v6, 0x4280, v6
  v_cndmask_b32 v6, v6, v5, vcc
  v_lshlrev_b32 v6, 1, v6
  v_add_u32 v125, 161024, v6
  v_add_u32 v5, 3, v4
  v_cvt_f32_u32 v6, v5
  v_cmp_gt_u32 vcc, 128, v5
  v_cvt_pk_bf16_f32 v6, v6, v6
  v_and_b32 v6, 0xffff, v6
  v_subrev_u32 v6, 0x4280, v6
  v_cndmask_b32 v6, v6, v5, vcc
  v_lshlrev_b32 v6, 1, v6
  v_add_u32 v126, 161024, v6
  v_add_u32 v5, 4, v4
  v_cvt_f32_u32 v6, v5
  v_cmp_gt_u32 vcc, 128, v5
  v_cvt_pk_bf16_f32 v6, v6, v6
  v_and_b32 v6, 0xffff, v6
  v_subrev_u32 v6, 0x4280, v6
  v_cndmask_b32 v6, v6, v5, vcc
  v_lshlrev_b32 v6, 1, v6
  v_add_u32 v127, 161024, v6
  v_add_u32 v5, 5, v4
  v_cvt_f32_u32 v6, v5
  v_cmp_gt_u32 vcc, 128, v5
  v_cvt_pk_bf16_f32 v6, v6, v6
  v_and_b32 v6, 0xffff, v6
  v_subrev_u32 v6, 0x4280, v6
  v_cndmask_b32 v6, v6, v5, vcc
  v_lshlrev_b32 v6, 1, v6
  v_add_u32 v242, 161024, v6
  v_add_u32 v5, 6, v4
  v_cvt_f32_u32 v6, v5
  v_cmp_gt_u32 vcc, 128, v5
  v_cvt_pk_bf16_f32 v6, v6, v6
  v_and_b32 v6, 0xffff, v6
  v_subrev_u32 v6, 0x4280, v6
  v_cndmask_b32 v6, v6, v5, vcc
  v_lshlrev_b32 v6, 1, v6
  v_add_u32 v243, 161024, v6
  v_add_u32 v5, 7, v4
  v_cvt_f32_u32 v6, v5
  v_cmp_gt_u32 vcc, 128, v5
  v_cvt_pk_bf16_f32 v6, v6, v6
  v_and_b32 v6, 0xffff, v6
  v_subrev_u32 v6, 0x4280, v6
  v_cndmask_b32 v6, v6, v5, vcc
  v_lshlrev_b32 v6, 1, v6
  v_add_u32 v248, 161024, v6
  s_waitcnt vmcnt(4) lgkmcnt(0)
  v_add_u32 v254, 1, v254
  s_nop 0
  v_readfirstlane_b32 s63, v254
  s_barrier
  s_waitcnt vmcnt(0)
  s_lshl_b32 s40, s48, 5
  s_add_u32 s40, s40, 160960
  v_lshlrev_b32 v2, 3, v1
  v_add_u32 v3, s40, v2
  s_mov_b64 exec, 0xf
  ds_read_b64 v[24:25], v3
  s_lshl_b32 s40, s35, 6
  s_lshl_b32 s41, s48, 5
  s_add_u32 s40, s40, s41
  s_add_u32 s40, s40, 12582912
  s_waitcnt lgkmcnt(0)
  buffer_store_dwordx2 v[24:25], v2, s[16:19], s40 offen sc1
  s_mov_b64 exec, -1
  v_lshrrev_b32 v2, 2, v1
  v_and_b32 v2, 3, v2
  v_mul_u32_u24 v2, 1088, v2
  v_lshrrev_b32 v3, 4, v1
  v_lshlrev_b32 v3, 5, v3
  v_add_u32 v2, v2, v3
  v_and_b32 v3, 3, v1
  v_lshlrev_b32 v3, 3, v3
  v_add_u32 v2, v2, v3
  s_lshl_b32 s40, s48, 9
  s_add_u32 s40, s40, 147456
  v_add_u32 v2, s40, v2
  ds_read_b64_tr_b16 v[8:9], v2 offset:0
  ds_read_b64_tr_b16 v[10:11], v2 offset:4352
  ds_read_b64_tr_b16 v[12:13], v2 offset:128
  ds_read_b64_tr_b16 v[14:15], v2 offset:4480
  ds_read_b64_tr_b16 v[16:17], v2 offset:256
  ds_read_b64_tr_b16 v[18:19], v2 offset:4608
  ds_read_b64_tr_b16 v[20:21], v2 offset:384
  ds_read_b64_tr_b16 v[22:23], v2 offset:4736
  s_lshl_b32 s40, s35, 13
  s_lshl_b32 s41, s48, 12
  s_add_u32 s40, s40, s41
  s_add_u32 s40, s40, 0
  v_lshlrev_b32 v3, 4, v1
  s_waitcnt lgkmcnt(6)
  buffer_store_dwordx4 v[8:11], v3, s[16:19], s40 offen offset:0 sc1
  s_waitcnt lgkmcnt(4)
  buffer_store_dwordx4 v[12:15], v3, s[16:19], s40 offen offset:1024 sc1
  s_waitcnt lgkmcnt(2)
  buffer_store_dwordx4 v[16:19], v3, s[16:19], s40 offen offset:2048 sc1
  s_waitcnt lgkmcnt(0)
  buffer_store_dwordx4 v[20:23], v3, s[16:19], s40 offen offset:3072 sc1
  s_lshl_b32 s42, s62, 16
  s_and_b32 s43, s62, 0xffff0000
  s_cmp_eq_u32 s48, 0
  s_cselect_b32 s42, s42, s43
  v_mov_b32 v76, s42
  s_mov_b32 s58, 0x3fb8aa3b
  s_mov_b32 s59, 0x32a57060
  v_mul_f32 v78, s58, v76
  v_fma_f32 v79, s58, v76, -v78
  v_fmac_f32 v79, s59, v76
  v_exp_f32 v77, v78
  v_mul_f32 v79, 0x3f317218, v79
  v_fmac_f32 v77, v77, v79
  v_cvt_pk_bf16_f32 v77, v77, v77
  v_and_b32 v77, 0xffff0000, v77
  v_lshlrev_b32 v80, 16, v244
  v_and_b32 v81, 0xffff0000, v244
  s_mov_b32 s58, 0x3fb8aa3b
  s_mov_b32 s59, 0x32a57060
  v_mul_f32 v78, s58, v80
  v_fma_f32 v79, s58, v80, -v78
  v_fmac_f32 v79, s59, v80
  v_exp_f32 v82, v78
  v_mul_f32 v79, 0x3f317218, v79
  v_fmac_f32 v82, v82, v79
  s_mov_b32 s58, 0x3fb8aa3b
  s_mov_b32 s59, 0x32a57060
  v_mul_f32 v78, s58, v81
  v_fma_f32 v79, s58, v81, -v78
  v_fmac_f32 v79, s59, v81
  v_exp_f32 v83, v78
  v_mul_f32 v79, 0x3f317218, v79
  v_fmac_f32 v83, v83, v79
  v_cvt_pk_bf16_f32 v82, v82, v82
  v_and_b32 v82, 0xffff0000, v82
  s_barrier
  s_waitcnt vmcnt(4)
  s_lshr_b32 s40, s35, 4
  s_lshl_b32 s40, s40, 7
  s_and_b32 s41, s35, 15
  s_lshl_b32 s41, s41, 3
  s_add_u32 s40, s40, s41
  s_lshl_b32 s41, s48, 2
  s_add_u32 s40, s40, s41
  s_add_u32 s40, s40, 12681216
  s_mov_b64 exec, 1
  v_mov_b32 v250, s63
  v_mov_b32 v251, 0
  buffer_store_dword v250, v251, s[16:19], s40 offen sc1
  s_mov_b64 exec, -1
  v_cvt_pk_bf16_f32 v83, v83, v83
  v_and_b32 v83, 0xffff0000, v83
  v_mul_f32 v82, v82, v77
  v_mul_f32 v83, v83, v77
  v_lshlrev_b32 v80, 16, v245
  v_and_b32 v81, 0xffff0000, v245
  v_mul_f32 v80, v80, v77
  v_mul_f32 v81, v81, v77
  v_mul_f32 v40, 0xbfb8aa3b, v82
  v_mul_f32 v42, 0xbfb8aa3b, v83
  v_mul_f32 v41, 0x3e22f983, v80
  v_mul_f32 v43, 0x3e22f983, v81
  v_lshlrev_b32 v44, 16, v246
  v_lshlrev_b32 v45, 16, v247
  v_and_b32 v46, 0xffff0000, v246
  v_and_b32 v47, 0xffff0000, v247
  v_add_f32 v77, v77, v77
  s_nop 0
  v_readfirstlane_b32 s60, v77
  v_mul_f32 v72, 0x41000000, v40
  v_mul_f32 v73, 0x41000000, v41
  v_mul_f32 v74, 0x41000000, v42
  v_mul_f32 v75, 0x41000000, v43
  v_exp_f32 v72, v72
  v_fract_f32 v73, v73
  v_exp_f32 v74, v74
  v_fract_f32 v75, v75
  v_cos_f32 v52, v73
  v_sin_f32 v53, v73
  v_cos_f32 v54, v75
  v_sin_f32 v55, v75
  s_nop 0
  v_mul_f32 v52, v52, v72
  v_mul_f32 v53, v53, v72
  v_mul_f32 v54, v54, v74
  v_mul_f32 v55, v55, v74
  v_mul_f32 v72, 0x3f800000, v40
  v_mul_f32 v73, 0x3f800000, v41
  v_mul_f32 v74, 0x3f800000, v42
  v_mul_f32 v75, 0x3f800000, v43
  v_exp_f32 v72, v72
  v_fract_f32 v73, v73
  v_exp_f32 v74, v74
  v_fract_f32 v75, v75
  v_cos_f32 v48, v73
  v_sin_f32 v49, v73
  v_cos_f32 v50, v75
  v_sin_f32 v51, v75
  s_nop 0
  v_mul_f32 v48, v48, v72
  v_mul_f32 v49, v49, v72
  v_mul_f32 v50, v50, v74
  v_mul_f32 v51, v51, v74
  v_mul_f32 v72, 0x43000000, v40
  v_mul_f32 v73, 0x43000000, v41
  v_mul_f32 v74, 0x43000000, v42
  v_mul_f32 v75, 0x43000000, v43
  v_exp_f32 v72, v72
  v_fract_f32 v73, v73
  v_exp_f32 v74, v74
  v_fract_f32 v75, v75
  v_cos_f32 v56, v73
  v_sin_f32 v57, v73
  v_cos_f32 v58, v75
  v_sin_f32 v59, v75
  s_nop 0
  v_mul_f32 v56, v56, v72
  v_mul_f32 v57, v57, v72
  v_mul_f32 v58, v58, v74
  v_mul_f32 v59, v59, v74
  v_mul_f32 v72, 0x43800000, v40
  v_mul_f32 v73, 0x43800000, v41
  v_mul_f32 v74, 0x43800000, v42
  v_mul_f32 v75, 0x43800000, v43
  v_exp_f32 v72, v72
  v_fract_f32 v73, v73
  v_exp_f32 v74, v74
  v_fract_f32 v75, v75
  v_cos_f32 v60, v73
  v_sin_f32 v61, v73
  v_cos_f32 v62, v75
  v_sin_f32 v63, v75
  s_nop 0
  v_mul_f32 v60, v60, v72
  v_mul_f32 v61, v61, v72
  v_mul_f32 v62, v62, v74
  v_mul_f32 v63, v63, v74
  v_mul_f32 v72, 0x44000000, v40
  v_mul_f32 v73, 0x44000000, v41
  v_mul_f32 v74, 0x44000000, v42
  v_mul_f32 v75, 0x44000000, v43
  v_exp_f32 v72, v72
  v_fract_f32 v73, v73
  v_exp_f32 v74, v74
  v_fract_f32 v75, v75
  v_cos_f32 v64, v73
  v_sin_f32 v65, v73
  v_cos_f32 v66, v75
  v_sin_f32 v67, v75
  s_nop 0
  v_mul_f32 v64, v64, v72
  v_mul_f32 v65, v65, v72
  v_mul_f32 v66, v66, v74
  v_mul_f32 v67, v67, v74
  v_mul_f32 v72, 0x44800000, v40
  v_mul_f32 v73, 0x44800000, v41
  s_waitcnt vmcnt(0)
  s_barrier
  s_cmp_eq_u32 s48, 0
  s_cbranch_scc0 L_NOF1_18
  s_lshl_b32 s40, s35, 2
  s_add_u32 s40, s40, 12697600
  s_mov_b64 exec, 1
  v_mov_b32 v250, s63
  v_mov_b32 v251, 0
  buffer_store_dword v250, v251, s[16:19], s40 offen sc1
  s_mov_b64 exec, -1
L_NOF1_18:
  s_cmp_eq_u32 s48, 0
  s_cbranch_scc0 L_NOPCS_19
  s_cmp_eq_u32 s33, 15
  s_cbranch_scc1 L_NOPCS_19
  v_lshlrev_b32 v2, 4, v1
  v_add_u32 v3, 158592, v2
  s_mov_b32 exec_lo, -1
  s_mov_b32 exec_hi, 0xffff
  ds_read_b128 v[24:27], v3
  ds_read_b128 v[28:31], v3 offset:768
  s_lshl_b32 s40, s33, 1
  s_lshr_b32 s41, s32, 3
  s_add_u32 s40, s40, s41
  s_lshl_b32 s40, s40, 3
  s_and_b32 s41, s32, 7
  s_add_u32 s40, s40, s41
  s_mul_i32 s40, s40, 768
  s_add_u32 s40, s40, 12713984
  s_waitcnt lgkmcnt(0)
  v_add_f32 v24, v24, v28
  v_add_f32 v25, v25, v29
  v_add_f32 v26, v26, v30
  v_add_f32 v27, v27, v31
  buffer_store_dwordx4 v[24:27], v2, s[16:19], s40 offen sc1
  s_mov_b64 exec, -1
L_NOPCS_19:
  v_mul_f32 v74, 0x44800000, v42
  v_mul_f32 v75, 0x44800000, v43
  v_exp_f32 v72, v72
  v_fract_f32 v73, v73
  v_exp_f32 v74, v74
  v_fract_f32 v75, v75
  v_cos_f32 v68, v73
  v_sin_f32 v69, v73
  v_cos_f32 v70, v75
  v_sin_f32 v71, v75
  s_nop 0
  v_mul_f32 v68, v68, v72
  v_mul_f32 v69, v69, v72
  v_mul_f32 v70, v70, v74
  v_mul_f32 v71, v71, v74
  v_mov_b32 v80, v44
  v_mov_b32 v81, v45
  v_mov_b32 v82, v46
  v_mov_b32 v83, v47
  v_mov_b32 v210, 0x3f80
  v_mov_b32 v211, 0x3f80
  v_cvt_pk_bf16_f32 v212, v52, -v53
  v_cvt_pk_bf16_f32 v213, v54, -v55
  v_cvt_pk_bf16_f32 v128, v80, v81
  v_cvt_pk_bf16_f32 v129, v82, v83
  v_mul_f32 v72, v52, v52
  v_mul_f32 v73, v52, v53
  v_mul_f32 v74, v54, v54
  v_mul_f32 v75, v54, v55
  v_fma_f32 v76, -v53, v53, v72
  v_fma_f32 v77, v53, v52, v73
  v_fma_f32 v78, -v55, v55, v74
  v_fma_f32 v79, v55, v54, v75
  v_cvt_pk_bf16_f32 v214, v76, -v77
  v_cvt_pk_bf16_f32 v215, v78, -v79
  v_mul_f32 v72, v80, v68
  v_mul_f32 v73, v80, v69
  v_mul_f32 v74, v82, v70
  v_mul_f32 v75, v82, v71
  v_fma_f32 v112, -v81, v69, v72
  v_fma_f32 v113, v81, v68, v73
  v_fma_f32 v114, -v83, v71, v74
  v_fma_f32 v115, v83, v70, v75
  v_cvt_pk_bf16_f32 v192, v112, v113
  v_cvt_pk_bf16_f32 v193, v114, v115
  v_mul_f32 v72, v76, v52
  v_mul_f32 v73, v76, v53
  v_mul_f32 v74, v78, v54
  v_mul_f32 v75, v78, v55
  v_fma_f32 v76, -v77, v53, v72
  v_fma_f32 v77, v77, v52, v73
  v_fma_f32 v78, -v79, v55, v74
  v_fma_f32 v79, v79, v54, v75
  v_cvt_pk_bf16_f32 v216, v76, -v77
  v_cvt_pk_bf16_f32 v217, v78, -v79
  v_mul_f32 v72, v80, v48
  v_mul_f32 v73, v80, v49
  v_mul_f32 v74, v82, v50
  v_mul_f32 v75, v82, v51
  v_fma_f32 v84, -v81, v49, v72
  v_fma_f32 v85, v81, v48, v73
  v_fma_f32 v86, -v83, v51, v74
  v_fma_f32 v87, v83, v50, v75
  v_cvt_pk_bf16_f32 v130, v84, v85
  v_cvt_pk_bf16_f32 v131, v86, v87
  v_mul_f32 v72, v112, v56
  v_mul_f32 v73, v112, v57
  v_mul_f32 v74, v114, v58
  v_mul_f32 v75, v114, v59
  v_fma_f32 v112, -v113, v57, v72
  v_fma_f32 v113, v113, v56, v73
  v_fma_f32 v114, -v115, v59, v74
  v_fma_f32 v115, v115, v58, v75
  v_cvt_pk_bf16_f32 v194, v112, v113
  v_cvt_pk_bf16_f32 v195, v114, v115
  v_mul_f32 v72, v76, v52
  v_mul_f32 v73, v76, v53
  s_barrier
  s_cmp_eq_u32 s48, 0
  s_cbranch_scc0 L_NOFC_20
  s_cmp_eq_u32 s33, 15
  s_cbranch_scc1 L_NOFC_20
  s_waitcnt vmcnt(0)
  s_lshl_b32 s40, s33, 1
  s_lshr_b32 s41, s32, 3
  s_add_u32 s40, s40, s41
  s_lshl_b32 s40, s40, 7
  s_and_b32 s41, s32, 7
  s_lshl_b32 s41, s41, 2
  s_add_u32 s40, s40, s41
  s_add_u32 s40, s40, 12683264
  s_mov_b64 exec, 1
  v_mov_b32 v250, s63
  v_mov_b32 v251, 0
  buffer_store_dword v250, v251, s[16:19], s40 offen sc1
  s_mov_b64 exec, -1
L_NOFC_20:
  v_mul_f32 v74, v78, v54
  v_mul_f32 v75, v78, v55
  v_fma_f32 v76, -v77, v53, v72
  v_fma_f32 v77, v77, v52, v73
  v_fma_f32 v78, -v79, v55, v74
  v_fma_f32 v79, v79, v54, v75
  v_cvt_pk_bf16_f32 v218, v76, -v77
  v_cvt_pk_bf16_f32 v219, v78, -v79
  v_mul_f32 v72, v84, v48
  v_mul_f32 v73, v84, v49
  v_mul_f32 v74, v86, v50
  v_mul_f32 v75, v86, v51
  v_fma_f32 v88, -v85, v49, v72
  v_fma_f32 v89, v85, v48, v73
  v_fma_f32 v90, -v87, v51, v74
  v_fma_f32 v91, v87, v50, v75
  v_cvt_pk_bf16_f32 v132, v88, v89
  v_cvt_pk_bf16_f32 v133, v90, v91
  v_mul_f32 v72, v112, v56
  v_mul_f32 v73, v112, v57
  v_mul_f32 v74, v114, v58
  v_mul_f32 v75, v114, v59
  v_fma_f32 v112, -v113, v57, v72
  v_fma_f32 v113, v113, v56, v73
  v_fma_f32 v114, -v115, v59, v74
  v_fma_f32 v115, v115, v58, v75
  v_cvt_pk_bf16_f32 v196, v112, v113
  v_cvt_pk_bf16_f32 v197, v114, v115
  v_mul_f32 v72, v76, v52
  v_mul_f32 v73, v76, v53
  v_mul_f32 v74, v78, v54
  v_mul_f32 v75, v78, v55
  v_fma_f32 v76, -v77, v53, v72
  v_fma_f32 v77, v77, v52, v73
  v_fma_f32 v78, -v79, v55, v74
  v_fma_f32 v79, v79, v54, v75
  v_cvt_pk_bf16_f32 v220, v76, -v77
  v_cvt_pk_bf16_f32 v221, v78, -v79
  v_mul_f32 v72, v88, v48
  v_mul_f32 v73, v88, v49
  v_mul_f32 v74, v90, v50
  v_mul_f32 v75, v90, v51
  v_fma_f32 v92, -v89, v49, v72
  v_fma_f32 v93, v89, v48, v73
  v_fma_f32 v94, -v91, v51, v74
  v_fma_f32 v95, v91, v50, v75
  v_cvt_pk_bf16_f32 v134, v92, v93
  v_cvt_pk_bf16_f32 v135, v94, v95
  v_mul_f32 v72, v112, v56
  v_mul_f32 v73, v112, v57
  v_mul_f32 v74, v114, v58
  v_mul_f32 v75, v114, v59
  v_fma_f32 v112, -v113, v57, v72
  v_fma_f32 v113, v113, v56, v73
  v_fma_f32 v114, -v115, v59, v74
  v_fma_f32 v115, v115, v58, v75
  v_cvt_pk_bf16_f32 v198, v112, v113
  v_cvt_pk_bf16_f32 v199, v114, v115
  v_mul_f32 v72, v76, v52
  v_mul_f32 v73, v76, v53
  v_mul_f32 v74, v78, v54
  v_mul_f32 v75, v78, v55
  v_fma_f32 v76, -v77, v53, v72
  v_fma_f32 v77, v77, v52, v73
  v_fma_f32 v78, -v79, v55, v74
  v_fma_f32 v79, v79, v54, v75
  v_cvt_pk_bf16_f32 v222, v76, -v77
  v_cvt_pk_bf16_f32 v223, v78, -v79
  v_mul_f32 v72, v92, v48
  v_mul_f32 v73, v92, v49
  v_mul_f32 v74, v94, v50
  v_mul_f32 v75, v94, v51
  v_fma_f32 v96, -v93, v49, v72
  v_fma_f32 v97, v93, v48, v73
  v_fma_f32 v98, -v95, v51, v74
  v_fma_f32 v99, v95, v50, v75
  v_cvt_pk_bf16_f32 v136, v96, v97
  v_cvt_pk_bf16_f32 v137, v98, v99
  v_mul_f32 v72, v112, v56
  v_mul_f32 v73, v112, v57
  v_mul_f32 v74, v114, v58
  v_mul_f32 v75, v114, v59
  v_fma_f32 v112, -v113, v57, v72
  v_fma_f32 v113, v113, v56, v73
  v_fma_f32 v114, -v115, v59, v74
  v_fma_f32 v115, v115, v58, v75
  v_cvt_pk_bf16_f32 v200, v112, v113
  v_cvt_pk_bf16_f32 v201, v114, v115
  v_mul_f32 v72, v76, v52
  v_mul_f32 v73, v76, v53
  v_mul_f32 v74, v78, v54
  v_mul_f32 v75, v78, v55
  s_barrier
  v_fma_f32 v76, -v77, v53, v72
  v_fma_f32 v77, v77, v52, v73
  v_fma_f32 v78, -v79, v55, v74
  v_fma_f32 v79, v79, v54, v75
  v_cvt_pk_bf16_f32 v224, v76, -v77
  v_cvt_pk_bf16_f32 v225, v78, -v79
  v_mul_f32 v72, v96, v48
  v_mul_f32 v73, v96, v49
  v_mul_f32 v74, v98, v50
  v_mul_f32 v75, v98, v51
  v_fma_f32 v100, -v97, v49, v72
  v_fma_f32 v101, v97, v48, v73
  v_fma_f32 v102, -v99, v51, v74
  v_fma_f32 v103, v99, v50, v75
  v_cvt_pk_bf16_f32 v138, v100, v101
  v_cvt_pk_bf16_f32 v139, v102, v103
  v_mul_f32 v72, v112, v56
  v_mul_f32 v73, v112, v57
  v_mul_f32 v74, v114, v58
  v_mul_f32 v75, v114, v59
  v_fma_f32 v112, -v113, v57, v72
  v_fma_f32 v113, v113, v56, v73
  v_fma_f32 v114, -v115, v59, v74
  v_fma_f32 v115, v115, v58, v75
  v_cvt_pk_bf16_f32 v202, v112, v113
  v_cvt_pk_bf16_f32 v203, v114, v115
  v_mul_f32 v72, v76, v52
  v_mul_f32 v73, v76, v53
  v_mul_f32 v74, v78, v54
  v_mul_f32 v75, v78, v55
  v_fma_f32 v76, -v77, v53, v72
  v_fma_f32 v77, v77, v52, v73
  v_fma_f32 v78, -v79, v55, v74
  v_fma_f32 v79, v79, v54, v75
  v_cvt_pk_bf16_f32 v226, v76, -v77
  v_cvt_pk_bf16_f32 v227, v78, -v79
  v_mul_f32 v72, v100, v48
  v_mul_f32 v73, v100, v49
  v_mul_f32 v74, v102, v50
  v_mul_f32 v75, v102, v51
  v_fma_f32 v104, -v101, v49, v72
  v_fma_f32 v105, v101, v48, v73
  v_fma_f32 v106, -v103, v51, v74
  v_fma_f32 v107, v103, v50, v75
  v_cvt_pk_bf16_f32 v140, v104, v105
  v_cvt_pk_bf16_f32 v141, v106, v107
  v_mul_f32 v72, v112, v56
  v_mul_f32 v73, v112, v57
  v_mul_f32 v74, v114, v58
  v_mul_f32 v75, v114, v59
  v_fma_f32 v112, -v113, v57, v72
  v_fma_f32 v113, v113, v56, v73
  v_fma_f32 v114, -v115, v59, v74
  v_fma_f32 v115, v115, v58, v75
  v_cvt_pk_bf16_f32 v204, v112, v113
  v_cvt_pk_bf16_f32 v205, v114, v115
  v_mul_f32 v72, v76, v52
  v_mul_f32 v73, v76, v53
  v_mul_f32 v74, v78, v54
  v_mul_f32 v75, v78, v55
  v_fma_f32 v76, -v77, v53, v72
  v_fma_f32 v77, v77, v52, v73
  v_fma_f32 v78, -v79, v55, v74
  v_fma_f32 v79, v79, v54, v75
  v_cvt_pk_bf16_f32 v228, v76, -v77
  v_cvt_pk_bf16_f32 v229, v78, -v79
  v_mul_f32 v72, v104, v48
  v_mul_f32 v73, v104, v49
  v_mul_f32 v74, v106, v50
  v_mul_f32 v75, v106, v51
  v_fma_f32 v108, -v105, v49, v72
  v_fma_f32 v109, v105, v48, v73
  v_fma_f32 v110, -v107, v51, v74
  v_fma_f32 v111, v107, v50, v75
  v_cvt_pk_bf16_f32 v142, v108, v109
  v_cvt_pk_bf16_f32 v143, v110, v111
  v_mul_f32 v72, v112, v56
  v_mul_f32 v73, v112, v57
  v_mul_f32 v74, v114, v58
  v_mul_f32 v75, v114, v59
  v_fma_f32 v112, -v113, v57, v72
  v_fma_f32 v113, v113, v56, v73
  v_fma_f32 v114, -v115, v59, v74
  v_fma_f32 v115, v115, v58, v75
  v_cvt_pk_bf16_f32 v206, v112, v113
  v_cvt_pk_bf16_f32 v207, v114, v115
  v_mul_f32 v72, v76, v52
  v_mul_f32 v73, v76, v53
  v_mul_f32 v74, v78, v54
  v_mul_f32 v75, v78, v55
  v_fma_f32 v76, -v77, v53, v72
  v_fma_f32 v77, v77, v52, v73
  v_fma_f32 v78, -v79, v55, v74
  v_fma_f32 v79, v79, v54, v75
  v_cvt_pk_bf16_f32 v230, v76, -v77
  v_cvt_pk_bf16_f32 v231, v78, -v79
  v_mul_f32 v72, v112, v56
  v_mul_f32 v73, v112, v57
  v_mul_f32 v74, v114, v58
  s_barrier
  v_mul_f32 v75, v114, v59
  v_fma_f32 v112, -v113, v57, v72
  v_fma_f32 v113, v113, v56, v73
  v_fma_f32 v114, -v115, v59, v74
  v_fma_f32 v115, v115, v58, v75
  v_cvt_pk_bf16_f32 v208, v112, v113
  v_cvt_pk_bf16_f32 v209, v114, v115
  v_mul_f32 v72, v76, v52
  v_mul_f32 v73, v76, v53
  v_mul_f32 v74, v78, v54
  v_mul_f32 v75, v78, v55
  v_fma_f32 v76, -v77, v53, v72
  v_fma_f32 v77, v77, v52, v73
  v_fma_f32 v78, -v79, v55, v74
  v_fma_f32 v79, v79, v54, v75
  v_cvt_pk_bf16_f32 v232, v76, -v77
  v_cvt_pk_bf16_f32 v233, v78, -v79
  v_mul_f32 v72, v76, v52
  v_mul_f32 v73, v76, v53
  v_mul_f32 v74, v78, v54
  v_mul_f32 v75, v78, v55
  v_fma_f32 v76, -v77, v53, v72
  v_fma_f32 v77, v77, v52, v73
  v_fma_f32 v78, -v79, v55, v74
  v_fma_f32 v79, v79, v54, v75
  v_cvt_pk_bf16_f32 v234, v76, -v77
  v_cvt_pk_bf16_f32 v235, v78, -v79
  v_mul_f32 v72, v76, v52
  v_mul_f32 v73, v76, v53
  v_mul_f32 v74, v78, v54
  v_mul_f32 v75, v78, v55
  v_fma_f32 v76, -v77, v53, v72
  v_fma_f32 v77, v77, v52, v73
  v_fma_f32 v78, -v79, v55, v74
  v_fma_f32 v79, v79, v54, v75
  v_cvt_pk_bf16_f32 v236, v76, -v77
  v_cvt_pk_bf16_f32 v237, v78, -v79
  v_mul_f32 v72, v76, v52
  v_mul_f32 v73, v76, v53
  v_mul_f32 v74, v78, v54
  v_mul_f32 v75, v78, v55
  v_fma_f32 v76, -v77, v53, v72
  v_fma_f32 v77, v77, v52, v73
  v_fma_f32 v78, -v79, v55, v74
  v_fma_f32 v79, v79, v54, v75
  v_cvt_pk_bf16_f32 v238, v76, -v77
  v_cvt_pk_bf16_f32 v239, v78, -v79
  v_mul_f32 v72, v76, v52
  v_mul_f32 v73, v76, v53
  v_mul_f32 v74, v78, v54
  v_mul_f32 v75, v78, v55
  v_fma_f32 v76, -v77, v53, v72
  v_fma_f32 v77, v77, v52, v73
  v_fma_f32 v78, -v79, v55, v74
  v_fma_f32 v79, v79, v54, v75
  v_cvt_pk_bf16_f32 v240, v76, -v77
  v_cvt_pk_bf16_f32 v241, v78, -v79
  v_mul_f32 v72, v80, v56
  v_mul_f32 v73, v80, v57
  v_mul_f32 v74, v82, v58
  v_mul_f32 v75, v82, v59
  v_fma_f32 v112, -v81, v57, v72
  v_fma_f32 v113, v81, v56, v73
  v_fma_f32 v114, -v83, v59, v74
  v_fma_f32 v115, v83, v58, v75
  v_cvt_pk_bf16_f32 v144, v112, v113
  v_cvt_pk_bf16_f32 v145, v114, v115
  v_mul_f32 v72, v84, v56
  v_mul_f32 v73, v84, v57
  v_mul_f32 v74, v86, v58
  v_mul_f32 v75, v86, v59
  v_fma_f32 v116, -v85, v57, v72
  v_fma_f32 v117, v85, v56, v73
  v_fma_f32 v118, -v87, v59, v74
  v_fma_f32 v119, v87, v58, v75
  v_cvt_pk_bf16_f32 v146, v116, v117
  v_cvt_pk_bf16_f32 v147, v118, v119
  v_mul_f32 v72, v88, v56
  v_mul_f32 v73, v88, v57
  v_mul_f32 v74, v90, v58
  v_mul_f32 v75, v90, v59
  v_fma_f32 v112, -v89, v57, v72
  v_fma_f32 v113, v89, v56, v73
  v_fma_f32 v114, -v91, v59, v74
  v_fma_f32 v115, v91, v58, v75
  v_cvt_pk_bf16_f32 v148, v112, v113
  v_cvt_pk_bf16_f32 v149, v114, v115
  v_mul_f32 v72, v92, v56
  v_mul_f32 v73, v92, v57
  v_mul_f32 v74, v94, v58
  v_mul_f32 v75, v94, v59
  v_fma_f32 v116, -v93, v57, v72
  v_fma_f32 v117, v93, v56, v73
  v_fma_f32 v118, -v95, v59, v74
  v_fma_f32 v119, v95, v58, v75
  v_cvt_pk_bf16_f32 v150, v116, v117
  v_cvt_pk_bf16_f32 v151, v118, v119
  v_mul_f32 v72, v96, v56
  v_mul_f32 v73, v96, v57
  s_barrier
  v_mul_f32 v74, v98, v58
  v_mul_f32 v75, v98, v59
  v_fma_f32 v112, -v97, v57, v72
  v_fma_f32 v113, v97, v56, v73
  v_fma_f32 v114, -v99, v59, v74
  v_fma_f32 v115, v99, v58, v75
  v_cvt_pk_bf16_f32 v152, v112, v113
  v_cvt_pk_bf16_f32 v153, v114, v115
  v_mul_f32 v72, v100, v56
  v_mul_f32 v73, v100, v57
  v_mul_f32 v74, v102, v58
  v_mul_f32 v75, v102, v59
  v_fma_f32 v116, -v101, v57, v72
  v_fma_f32 v117, v101, v56, v73
  v_fma_f32 v118, -v103, v59, v74
  v_fma_f32 v119, v103, v58, v75
  v_cvt_pk_bf16_f32 v154, v116, v117
  v_cvt_pk_bf16_f32 v155, v118, v119
  v_mul_f32 v72, v104, v56
  v_mul_f32 v73, v104, v57
  v_mul_f32 v74, v106, v58
  v_mul_f32 v75, v106, v59
  v_fma_f32 v112, -v105, v57, v72
  v_fma_f32 v113, v105, v56, v73
  v_fma_f32 v114, -v107, v59, v74
  v_fma_f32 v115, v107, v58, v75
  v_cvt_pk_bf16_f32 v156, v112, v113
  v_cvt_pk_bf16_f32 v157, v114, v115
  v_mul_f32 v72, v108, v56
  v_mul_f32 v73, v108, v57
  v_mul_f32 v74, v110, v58
  v_mul_f32 v75, v110, v59
  v_fma_f32 v116, -v109, v57, v72
  v_fma_f32 v117, v109, v56, v73
  v_fma_f32 v118, -v111, v59, v74
  v_fma_f32 v119, v111, v58, v75
  v_cvt_pk_bf16_f32 v158, v116, v117
  v_cvt_pk_bf16_f32 v159, v118, v119
  v_mul_f32 v72, v80, v60
  v_mul_f32 v73, v80, v61
  v_mul_f32 v74, v82, v62
  v_mul_f32 v75, v82, v63
  v_fma_f32 v112, -v81, v61, v72
  v_fma_f32 v113, v81, v60, v73
  v_fma_f32 v114, -v83, v63, v74
  v_fma_f32 v115, v83, v62, v75
  v_cvt_pk_bf16_f32 v160, v112, v113
  v_cvt_pk_bf16_f32 v161, v114, v115
  v_mul_f32 v72, v112, v56
  v_mul_f32 v73, v112, v57
  v_mul_f32 v74, v114, v58
  v_mul_f32 v75, v114, v59
  v_fma_f32 v116, -v113, v57, v72
  v_fma_f32 v117, v113, v56, v73
  v_fma_f32 v118, -v115, v59, v74
  v_fma_f32 v119, v115, v58, v75
  v_cvt_pk_bf16_f32 v168, v116, v117
  v_cvt_pk_bf16_f32 v169, v118, v119
  v_mul_f32 v72, v88, v60
  v_mul_f32 v73, v88, v61
  v_mul_f32 v74, v90, v62
  v_mul_f32 v75, v90, v63
  v_fma_f32 v112, -v89, v61, v72
  v_fma_f32 v113, v89, v60, v73
  v_fma_f32 v114, -v91, v63, v74
  v_fma_f32 v115, v91, v62, v75
  v_cvt_pk_bf16_f32 v162, v112, v113
  v_cvt_pk_bf16_f32 v163, v114, v115
  v_mul_f32 v72, v112, v56
  v_mul_f32 v73, v112, v57
  v_mul_f32 v74, v114, v58
  v_mul_f32 v75, v114, v59
  v_fma_f32 v116, -v113, v57, v72
  v_fma_f32 v117, v113, v56, v73
  v_fma_f32 v118, -v115, v59, v74
  v_fma_f32 v119, v115, v58, v75
  v_cvt_pk_bf16_f32 v170, v116, v117
  v_cvt_pk_bf16_f32 v171, v118, v119
  v_mul_f32 v72, v96, v60
  v_mul_f32 v73, v96, v61
  v_mul_f32 v74, v98, v62
  v_mul_f32 v75, v98, v63
  v_fma_f32 v112, -v97, v61, v72
  v_fma_f32 v113, v97, v60, v73
  v_fma_f32 v114, -v99, v63, v74
  v_fma_f32 v115, v99, v62, v75
  v_cvt_pk_bf16_f32 v164, v112, v113
  v_cvt_pk_bf16_f32 v165, v114, v115
  v_mul_f32 v72, v112, v56
  v_mul_f32 v73, v112, v57
  v_mul_f32 v74, v114, v58
  v_mul_f32 v75, v114, v59
  v_fma_f32 v116, -v113, v57, v72
  v_fma_f32 v117, v113, v56, v73
  v_fma_f32 v118, -v115, v59, v74
  v_fma_f32 v119, v115, v58, v75
  v_cvt_pk_bf16_f32 v172, v116, v117
  v_cvt_pk_bf16_f32 v173, v118, v119
  v_mul_f32 v72, v104, v60
  s_barrier
  v_mul_f32 v73, v104, v61
  v_mul_f32 v74, v106, v62
  v_mul_f32 v75, v106, v63
  v_fma_f32 v112, -v105, v61, v72
  v_fma_f32 v113, v105, v60, v73
  v_fma_f32 v114, -v107, v63, v74
  v_fma_f32 v115, v107, v62, v75
  v_cvt_pk_bf16_f32 v166, v112, v113
  v_cvt_pk_bf16_f32 v167, v114, v115
  v_mul_f32 v72, v112, v56
  v_mul_f32 v73, v112, v57
  v_mul_f32 v74, v114, v58
  v_mul_f32 v75, v114, v59
  v_fma_f32 v116, -v113, v57, v72
  v_fma_f32 v117, v113, v56, v73
  v_fma_f32 v118, -v115, v59, v74
  v_fma_f32 v119, v115, v58, v75
  v_cvt_pk_bf16_f32 v174, v116, v117
  v_cvt_pk_bf16_f32 v175, v118, v119
  v_mul_f32 v72, v80, v64
  v_mul_f32 v73, v80, v65
  v_mul_f32 v74, v82, v66
  v_mul_f32 v75, v82, v67
  v_fma_f32 v112, -v81, v65, v72
  v_fma_f32 v113, v81, v64, v73
  v_fma_f32 v114, -v83, v67, v74
  v_fma_f32 v115, v83, v66, v75
  v_mul_f32 v72, v96, v64
  v_mul_f32 v73, v96, v65
  v_mul_f32 v74, v98, v66
  v_mul_f32 v75, v98, v67
  v_fma_f32 v116, -v97, v65, v72
  v_fma_f32 v117, v97, v64, v73
  v_fma_f32 v118, -v99, v67, v74
  v_fma_f32 v119, v99, v66, v75
  v_cvt_pk_bf16_f32 v176, v112, v113
  v_cvt_pk_bf16_f32 v177, v114, v115
  v_cvt_pk_bf16_f32 v178, v116, v117
  v_cvt_pk_bf16_f32 v179, v118, v119
  v_mul_f32 v72, v112, v56
  v_mul_f32 v73, v112, v57
  v_mul_f32 v74, v114, v58
  v_mul_f32 v75, v114, v59
  v_fma_f32 v112, -v113, v57, v72
  v_fma_f32 v113, v113, v56, v73
  v_fma_f32 v114, -v115, v59, v74
  v_fma_f32 v115, v115, v58, v75
  v_mul_f32 v72, v116, v56
  v_mul_f32 v73, v116, v57
  v_mul_f32 v74, v118, v58
  v_mul_f32 v75, v118, v59
  v_fma_f32 v116, -v117, v57, v72
  v_fma_f32 v117, v117, v56, v73
  v_fma_f32 v118, -v119, v59, v74
  v_fma_f32 v119, v119, v58, v75
  v_cvt_pk_bf16_f32 v180, v112, v113
  v_cvt_pk_bf16_f32 v181, v114, v115
  v_cvt_pk_bf16_f32 v182, v116, v117
  v_cvt_pk_bf16_f32 v183, v118, v119
  v_mul_f32 v72, v112, v56
  v_mul_f32 v73, v112, v57
  v_mul_f32 v74, v114, v58
  v_mul_f32 v75, v114, v59
  v_fma_f32 v112, -v113, v57, v72
  v_fma_f32 v113, v113, v56, v73
  v_fma_f32 v114, -v115, v59, v74
  v_fma_f32 v115, v115, v58, v75
  v_mul_f32 v72, v116, v56
  v_mul_f32 v73, v116, v57
  v_mul_f32 v74, v118, v58
  v_mul_f32 v75, v118, v59
  v_fma_f32 v116, -v117, v57, v72
  v_fma_f32 v117, v117, v56, v73
  v_fma_f32 v118, -v119, v59, v74
  v_fma_f32 v119, v119, v58, v75
  v_cvt_pk_bf16_f32 v184, v112, v113
  v_cvt_pk_bf16_f32 v185, v114, v115
  v_cvt_pk_bf16_f32 v186, v116, v117
  v_cvt_pk_bf16_f32 v187, v118, v119
  v_mul_f32 v72, v112, v56
  v_mul_f32 v73, v112, v57
  v_mul_f32 v74, v114, v58
  v_mul_f32 v75, v114, v59
  v_fma_f32 v112, -v113, v57, v72
  v_fma_f32 v113, v113, v56, v73
  v_fma_f32 v114, -v115, v59, v74
  v_fma_f32 v115, v115, v58, v75
  v_mul_f32 v72, v116, v56
  v_mul_f32 v73, v116, v57
  v_mul_f32 v74, v118, v58
  v_mul_f32 v75, v118, v59
  v_fma_f32 v116, -v117, v57, v72
  v_fma_f32 v117, v117, v56, v73
  v_fma_f32 v118, -v119, v59, v74
  v_fma_f32 v119, v119, v58, v75
  v_cvt_pk_bf16_f32 v188, v112, v113
  v_cvt_pk_bf16_f32 v189, v114, v115
  v_cvt_pk_bf16_f32 v190, v116, v117
  v_cvt_pk_bf16_f32 v191, v118, v119
  s_mul_i32 s47, s48, 1344
  s_add_u32 s47, s47, 161024
  v_lshrrev_b32 v2, 4, v1
  v_and_b32 v3, 15, v1
  v_and_b32 v4, 1, v2
  v_lshlrev_b32 v4, 2, v4
  v_lshrrev_b32 v5, 1, v2
  v_lshlrev_b32 v5, 7, v5
  v_add_u32 v4, v4, v5
  v_lshlrev_b32 v5, 3, v3
  v_add_u32 v4, v4, v5
  v_add_u32 v32, 0, v4
  v_add_u32 v33, 1, v4
  v_add_u32 v34, 2, v4
  v_add_u32 v35, 3, v4
  v_cmp_gt_u32 vcc, 2, v2
  v_lshlrev_b32 v4, 6, v2
  v_lshlrev_b32 v5, 2, v3
  v_add_u32 v4, v4, v5
  v_add_u32 v4, 256, v4
  v_lshlrev_b32 v5, 6, v2
  v_lshlrev_b32 v6, 1, v3
  v_add_u32 v5, v5, v6
  v_add_u32 v5, 256, v5
  v_add_u32 v6, 0, v4
  v_add_u32 v7, 0, v5
  v_cndmask_b32 v36, v7, v6, vcc
  v_add_u32 v6, 1, v4
  v_add_u32 v7, 1, v5
  v_cndmask_b32 v37, v7, v6, vcc
  v_add_u32 v6, 2, v4
  v_add_u32 v7, 32, v5
  v_cndmask_b32 v38, v7, v6, vcc
  v_add_u32 v6, 3, v4
  v_add_u32 v7, 33, v5
  v_cndmask_b32 v39, v7, v6, vcc
  v_lshlrev_b32 v4, 6, v2
  v_add_u32 v4, v4, v3
  v_add_u32 v4, 512, v4
  v_mov_b32 v7, 660
  v_add_u32 v6, 0, v4
  v_cndmask_b32 v244, v7, v6, vcc
  v_add_u32 v6, 16, v4
  v_cndmask_b32 v245, v7, v6, vcc
  v_add_u32 v6, 32, v4
  v_cndmask_b32 v246, v7, v6, vcc
  v_add_u32 v6, 48, v4
  v_cndmask_b32 v247, v7, v6, vcc
  v_cmp_eq_u32 vcc, 32, v1
  v_mov_b32 v6, 640
  s_nop 0
  v_cndmask_b32 v244, v244, v6, vcc
  v_lshlrev_b32 v32, 1, v32
  v_add_u32 v32, s47, v32
  v_lshlrev_b32 v33, 1, v33
  v_add_u32 v33, s47, v33
  v_lshlrev_b32 v34, 1, v34
  v_add_u32 v34, s47, v34
  v_lshlrev_b32 v35, 1, v35
  v_add_u32 v35, s47, v35
  v_lshlrev_b32 v36, 1, v36
  v_add_u32 v36, s47, v36
  v_lshlrev_b32 v37, 1, v37
  v_add_u32 v37, s47, v37
  v_lshlrev_b32 v38, 1, v38
  v_add_u32 v38, s47, v38
  v_lshlrev_b32 v39, 1, v39
  v_add_u32 v39, s47, v39
  v_lshlrev_b32 v244, 1, v244
  v_add_u32 v244, s47, v244
  v_lshlrev_b32 v245, 1, v245
  v_add_u32 v245, s47, v245
  v_lshlrev_b32 v246, 1, v246
  v_add_u32 v246, s47, v246
  v_lshlrev_b32 v247, 1, v247
  v_add_u32 v247, s47, v247
  s_barrier
  s_barrier
  s_mul_i32 s46, s48, 17408
  s_add_u32 s46, s46, 49152
  v_lshlrev_b32 v6, 3, v1
  v_add_u32 v6, s46, v6
  ds_write_b64 v6, v[210:211] offset:0
  ds_write_b64 v6, v[212:213] offset:544
  ds_write_b64 v6, v[214:215] offset:1088
  ds_write_b64 v6, v[216:217] offset:1632
  ds_write_b64 v6, v[218:219] offset:2176
  ds_write_b64 v6, v[220:221] offset:2720
  ds_write_b64 v6, v[222:223] offset:3264
  ds_write_b64 v6, v[224:225] offset:3808
  ds_write_b64 v6, v[226:227] offset:4352
  ds_write_b64 v6, v[228:229] offset:4896
  ds_write_b64 v6, v[230:231] offset:5440
  ds_write_b64 v6, v[232:233] offset:5984
  ds_write_b64 v6, v[234:235] offset:6528
  ds_write_b64 v6, v[236:237] offset:7072
  ds_write_b64 v6, v[238:239] offset:7616
  ds_write_b64 v6, v[240:241] offset:8160
  ds_write_b64 v6, v[128:129] offset:8704
  ds_write_b64 v6, v[130:131] offset:9248
  ds_write_b64 v6, v[132:133] offset:9792
  ds_write_b64 v6, v[134:135] offset:10336
  ds_write_b64 v6, v[136:137] offset:10880
  ds_write_b64 v6, v[138:139] offset:11424
  ds_write_b64 v6, v[140:141] offset:11968
  ds_write_b64 v6, v[142:143] offset:12512
  ds_write_b64 v6, v[144:145] offset:13056
  ds_write_b64 v6, v[146:147] offset:13600
  ds_write_b64 v6, v[148:149] offset:14144
  ds_write_b64 v6, v[150:151] offset:14688
  ds_write_b64 v6, v[152:153] offset:15232
  ds_write_b64 v6, v[154:155] offset:15776
  ds_write_b64 v6, v[156:157] offset:16320
  ds_write_b64 v6, v[158:159] offset:16864
  v_and_b32 v24, 15, v1
  v_mul_u32_u24 v24, 544, v24
  v_lshrrev_b32 v25, 4, v1
  v_lshlrev_b32 v25, 4, v25
  v_add_u32 v24, v24, v25
  v_add_u32 v7, s46, v24
  ds_read_b128 v[52:55], v7 offset:0
  ds_read_b128 v[56:59], v7 offset:64
  ds_read_b128 v[60:63], v7 offset:128
  ds_read_b128 v[64:67], v7 offset:192
  ds_read_b128 v[68:71], v7 offset:256
  ds_read_b128 v[72:75], v7 offset:320
  ds_read_b128 v[76:79], v7 offset:384
  ds_read_b128 v[80:83], v7 offset:448
  ds_read_b128 v[84:87], v7 offset:8704
  ds_read_b128 v[88:91], v7 offset:8768
  ds_read_b128 v[92:95], v7 offset:8832
  ds_read_b128 v[96:99], v7 offset:8896
  ds_read_b128 v[100:103], v7 offset:8960
  ds_read_b128 v[104:107], v7 offset:9024
  ds_read_b128 v[108:111], v7 offset:9088
  ds_read_b128 v[112:115], v7 offset:9152
  ds_write_b64 v6, v[160:161] offset:8704
  ds_write_b64 v6, v[162:163] offset:9248
  ds_write_b64 v6, v[164:165] offset:9792
  ds_write_b64 v6, v[166:167] offset:10336
  ds_write_b64 v6, v[168:169] offset:10880
  ds_write_b64 v6, v[170:171] offset:11424
  ds_write_b64 v6, v[172:173] offset:11968
  ds_write_b64 v6, v[174:175] offset:12512
  ds_write_b64 v6, v[176:177] offset:13056
  ds_write_b64 v6, v[178:179] offset:13600
  ds_write_b64 v6, v[180:181] offset:14144
  ds_write_b64 v6, v[182:183] offset:14688
  ds_write_b64 v6, v[184:185] offset:15232
  ds_write_b64 v6, v[186:187] offset:15776
  ds_write_b64 v6, v[188:189] offset:16320
  ds_write_b64 v6, v[190:191] offset:16864
  s_waitcnt lgkmcnt(15)
  v_mfma_f32_16x16x32_bf16 v[8:11], v[84:87], v[52:55], 0
  v_mfma_f32_16x16x32_bf16 v[8:11], v[88:91], v[56:59], v[8:11]
  v_mfma_f32_16x16x32_bf16 v[8:11], v[92:95], v[60:63], v[8:11]
  v_mfma_f32_16x16x32_bf16 v[8:11], v[96:99], v[64:67], v[8:11]
  v_mfma_f32_16x16x32_bf16 v[8:11], v[100:103], v[68:71], v[8:11]
  v_mfma_f32_16x16x32_bf16 v[8:11], v[104:107], v[72:75], v[8:11]
  v_mfma_f32_16x16x32_bf16 v[8:11], v[108:111], v[76:79], v[8:11]
  v_mfma_f32_16x16x32_bf16 v[8:11], v[112:115], v[80:83], v[8:11]
  ds_read_b128 v[84:87], v7 offset:8704
  ds_read_b128 v[88:91], v7 offset:8768
  ds_read_b128 v[92:95], v7 offset:8832
  ds_read_b128 v[96:99], v7 offset:8896
  ds_read_b128 v[100:103], v7 offset:8960
  ds_read_b128 v[104:107], v7 offset:9024
  ds_read_b128 v[108:111], v7 offset:9088
  ds_read_b128 v[112:115], v7 offset:9152
  ds_write_b64 v6, v[192:193] offset:8704
  ds_write_b64 v6, v[194:195] offset:9248
  ds_write_b64 v6, v[196:197] offset:9792
  ds_write_b64 v6, v[198:199] offset:10336
  ds_write_b64 v6, v[200:201] offset:10880
  ds_write_b64 v6, v[202:203] offset:11424
  ds_write_b64 v6, v[204:205] offset:11968
  ds_write_b64 v6, v[206:207] offset:12512
  ds_write_b64 v6, v[208:209] offset:13056
  s_waitcnt lgkmcnt(9)
  v_mfma_f32_16x16x32_bf16 v[12:15], v[84:87], v[52:55], 0
  v_mfma_f32_16x16x32_bf16 v[12:15], v[88:91], v[56:59], v[12:15]
  v_mfma_f32_16x16x32_bf16 v[12:15], v[92:95], v[60:63], v[12:15]
  v_mfma_f32_16x16x32_bf16 v[12:15], v[96:99], v[64:67], v[12:15]
  v_mfma_f32_16x16x32_bf16 v[12:15], v[100:103], v[68:71], v[12:15]
  v_mfma_f32_16x16x32_bf16 v[12:15], v[104:107], v[72:75], v[12:15]
  v_mfma_f32_16x16x32_bf16 v[12:15], v[108:111], v[76:79], v[12:15]
  v_mfma_f32_16x16x32_bf16 v[12:15], v[112:115], v[80:83], v[12:15]
  ds_read_b128 v[84:87], v7 offset:8704
  ds_read_b128 v[88:91], v7 offset:8768
  ds_read_b128 v[92:95], v7 offset:8832
  ds_read_b128 v[96:99], v7 offset:8896
  ds_read_b128 v[100:103], v7 offset:8960
  ds_read_b128 v[104:107], v7 offset:9024
  ds_read_b128 v[108:111], v7 offset:9088
  ds_read_b128 v[112:115], v7 offset:9152
  s_waitcnt lgkmcnt(0)
  v_mfma_f32_16x16x32_bf16 v[16:19], v[84:87], v[52:55], 0
  v_mfma_f32_16x16x32_bf16 v[16:19], v[88:91], v[56:59], v[16:19]
  v_mfma_f32_16x16x32_bf16 v[16:19], v[92:95], v[60:63], v[16:19]
  v_mfma_f32_16x16x32_bf16 v[16:19], v[96:99], v[64:67], v[16:19]
  v_mfma_f32_16x16x32_bf16 v[16:19], v[100:103], v[68:71], v[16:19]
  v_mfma_f32_16x16x32_bf16 v[16:19], v[104:107], v[72:75], v[16:19]
  v_mfma_f32_16x16x32_bf16 v[16:19], v[108:111], v[76:79], v[16:19]
  v_mfma_f32_16x16x32_bf16 v[16:19], v[112:115], v[80:83], v[16:19]
  s_nop 7
  v_mul_f32 v8, s60, v8
  v_mul_f32 v9, s60, v9
  v_mul_f32 v10, s60, v10
  v_mul_f32 v11, s60, v11
  v_mul_f32 v12, s60, v12
  v_mul_f32 v13, s60, v13
  v_mul_f32 v14, s60, v14
  v_mul_f32 v15, s60, v15
  v_mul_f32 v16, s60, v16
  v_mul_f32 v17, s60, v17
  v_mul_f32 v18, s60, v18
  v_mul_f32 v19, s60, v19
  v_cvt_pk_bf16_f32 v8, v8, v9
  v_cvt_pk_bf16_f32 v10, v10, v11
  v_cvt_pk_bf16_f32 v12, v12, v13
  v_cvt_pk_bf16_f32 v14, v14, v15
  v_cvt_pk_bf16_f32 v16, v16, v17
  v_cvt_pk_bf16_f32 v18, v18, v19
  ds_write_b16 v32, v8
  ds_write_b16_d16_hi v33, v8
  ds_write_b16 v34, v10
  ds_write_b16_d16_hi v35, v10
  ds_write_b16 v36, v12
  ds_write_b16_d16_hi v37, v12
  ds_write_b16 v38, v14
  ds_write_b16_d16_hi v39, v14
  ds_write_b16 v244, v16
  ds_write_b16_d16_hi v245, v16
  ds_write_b16 v246, v18
  ds_write_b16_d16_hi v247, v18
  s_mul_i32 s47, s48, 1344
  s_add_u32 s47, s47, 161024
  v_mov_b32 v24, 0
  v_mov_b32 v25, s47
  s_mov_b64 exec, 1
  ds_write_b16 v25, v24 offset:1322
  s_mov_b64 exec, -1
  s_waitcnt lgkmcnt(0)
L_POST1:
  s_cmp_ge_u32 s3, 4
  s_cbranch_scc0 L_P_G2
  s_setprio 3
  s_waitcnt lgkmcnt(0)
  s_sub_u32 s40, s3, 4
  s_lshl_b32 s40, s40, 2
  s_add_u32 s40, s40, 160928
  v_mov_b32 v2, s40
  v_mov_b32 v3, 1
  ds_write_b32 v2, v3
  v_mov_b32 v2, 160928
  s_mov_b32 s57, 0
L_GS_21:
  ds_read_b128 v[4:7], v2
  s_waitcnt lgkmcnt(0)
  v_and_b32 v4, v4, v5
  v_and_b32 v6, v6, v7
  v_and_b32 v4, v4, v6
  s_add_u32 s57, s57, 1
  v_readfirstlane_b32 s40, v4
  s_cmp_gt_u32 s57, 1000000
  s_cbranch_scc1 L_GSD_22
  s_cmp_eq_u32 s40, 0
  s_cbranch_scc1 L_GS_21
L_GSD_22:
  ds_read_u16 v32, v120 offset:0
  ds_read_u16 v33, v121 offset:0
  ds_read_u16 v34, v122 offset:0
  ds_read_u16 v35, v123 offset:0
  ds_read_u16 v36, v124 offset:0
  ds_read_u16 v37, v125 offset:0
  ds_read_u16 v38, v126 offset:0
  ds_read_u16 v39, v127 offset:0
  ds_read_u16 v40, v242 offset:0
  ds_read_u16 v41, v243 offset:0
  ds_read_u16 v42, v248 offset:0
  ds_read_u16 v48, v120 offset:1344
  ds_read_u16 v49, v121 offset:1344
  ds_read_u16 v50, v122 offset:1344
  ds_read_u16 v51, v123 offset:1344
  ds_read_u16 v52, v124 offset:1344
  ds_read_u16 v53, v125 offset:1344
  ds_read_u16 v54, v126 offset:1344
  ds_read_u16 v55, v127 offset:1344
  ds_read_u16 v56, v242 offset:1344
  ds_read_u16 v57, v243 offset:1344
  ds_read_u16 v58, v248 offset:1344
  v_and_b32 v8, 255, v0
  v_lshlrev_b32 v9, 4, v8
  v_add_u32 v9, 49184, v9
  s_waitcnt lgkmcnt(11)
  v_lshl_or_b32 v64, v36, 16, v35
  v_lshl_or_b32 v65, v38, 16, v37
  v_lshl_or_b32 v66, v40, 16, v39
  v_lshl_or_b32 v67, v42, 16, v41
  v_lshl_or_b32 v68, v35, 16, v34
  v_lshl_or_b32 v69, v37, 16, v36
  v_lshl_or_b32 v70, v39, 16, v38
  v_lshl_or_b32 v71, v41, 16, v40
  v_lshl_or_b32 v72, v34, 16, v33
  v_lshl_or_b32 v73, v36, 16, v35
  v_lshl_or_b32 v74, v38, 16, v37
  v_lshl_or_b32 v75, v40, 16, v39
  v_lshl_or_b32 v76, v33, 16, v32
  v_lshl_or_b32 v77, v35, 16, v34
  v_lshl_or_b32 v78, v37, 16, v36
  v_lshl_or_b32 v79, v39, 16, v38
  ds_write_b128 v9, v[64:67] offset:0
  ds_write_b128 v9, v[68:71] offset:4160
  ds_write_b128 v9, v[72:75] offset:8320
  ds_write_b128 v9, v[76:79] offset:12480
  s_waitcnt lgkmcnt(4)
  v_lshl_or_b32 v80, v52, 16, v51
  v_lshl_or_b32 v81, v54, 16, v53
  v_lshl_or_b32 v82, v56, 16, v55
  v_lshl_or_b32 v83, v58, 16, v57
  v_lshl_or_b32 v84, v51, 16, v50
  v_lshl_or_b32 v85, v53, 16, v52
  v_lshl_or_b32 v86, v55, 16, v54
  v_lshl_or_b32 v87, v57, 16, v56
  v_lshl_or_b32 v88, v50, 16, v49
  v_lshl_or_b32 v89, v52, 16, v51
  v_lshl_or_b32 v90, v54, 16, v53
  v_lshl_or_b32 v91, v56, 16, v55
  v_lshl_or_b32 v92, v49, 16, v48
  v_lshl_or_b32 v93, v51, 16, v50
  v_lshl_or_b32 v94, v53, 16, v52
  v_lshl_or_b32 v95, v55, 16, v54
  ds_write_b128 v9, v[80:83] offset:16640
  ds_write_b128 v9, v[84:87] offset:20800
  ds_write_b128 v9, v[88:91] offset:24960
  ds_write_b128 v9, v[92:95] offset:29120
  v_cmp_gt_u32 vcc, 16, v8
  v_lshrrev_b32 v10, 3, v8
  v_mul_u32_u24 v10, 16640, v10
  v_lshrrev_b32 v11, 1, v8
  v_and_b32 v11, 3, v11
  v_mul_u32_u24 v11, 4160, v11
  v_add_u32 v10, v10, v11
  v_and_b32 v11, 1, v8
  v_lshlrev_b32 v11, 4, v11
  v_add_u32 v10, v10, v11
  v_add_u32 v10, 49152, v10
  v_mov_b32 v12, 0
  v_mov_b32 v13, 0
  v_mov_b32 v14, 0
  v_mov_b32 v15, 0
  s_and_saveexec_b64 s[40:41], vcc
  s_cbranch_execz L_NOPAD_23
  ds_write_b128 v10, v[12:15]
L_NOPAD_23:
  s_mov_b64 exec, s[40:41]
  s_waitcnt lgkmcnt(0)
  s_waitcnt lgkmcnt(0)
  s_sub_u32 s40, s3, 4
  s_lshl_b32 s40, s40, 2
  s_add_u32 s40, s40, 160896
  v_mov_b32 v2, s40
  v_mov_b32 v3, 1
  ds_write_b32 v2, v3
  v_mov_b32 v2, 160896
  s_mov_b32 s57, 0
L_GS_24:
  ds_read_b128 v[4:7], v2
  s_waitcnt lgkmcnt(0)
  v_and_b32 v4, v4, v5
  v_and_b32 v6, v6, v7
  v_and_b32 v4, v4, v6
  s_add_u32 s57, s57, 1
  v_readfirstlane_b32 s40, v4
  s_cmp_gt_u32 s57, 1000000
  s_cbranch_scc1 L_GSD_25
  s_cmp_eq_u32 s40, 0
  s_cbranch_scc1 L_GS_24
L_GSD_25:
  s_sub_u32 s55, s3, 4
  s_lshr_b32 s40, s55, 1
  s_and_b32 s41, s55, 1
  v_lshrrev_b32 v2, 4, v1
  v_lshrrev_b32 v3, 1, v2
  v_and_b32 v2, 1, v2
  v_lshlrev_b32 v4, 5, v3
  v_lshlrev_b32 v5, 4, v2
  v_lshrrev_b32 v6, 2, v1
  v_and_b32 v6, 3, v6
  v_mul_u32_u24 v6, 4160, v6
  v_add_u32 v6, v6, v4
  v_sub_u32 v6, v6, v5
  v_and_b32 v7, 3, v1
  v_lshlrev_b32 v7, 3, v7
  v_add_u32 v6, v6, v7
  s_mul_i32 s42, s40, 16640
  s_lshl_b32 s43, s41, 8
  s_add_u32 s42, s42, s43
  s_add_u32 s42, s42, 49176
  v_add_u32 v200, s42, v6
  v_and_b32 v6, 15, v1
  v_lshlrev_b32 v6, 5, v6
  v_sub_u32 v6, v6, v4
  v_add_u32 v6, v6, v5
  s_mul_i32 s42, s40, 4608
  s_lshl_b32 s43, s41, 8
  s_sub_u32 s42, s42, s43
  s_add_u32 s42, s42, 148736
  v_add_u32 v201, s42, v6
  v_mov_b32 v8, 0
  v_mov_b32 v9, 0
  v_mov_b32 v10, 0
  v_mov_b32 v11, 0
  v_mov_b32 v12, 0
  v_mov_b32 v13, 0
  v_mov_b32 v14, 0
  v_mov_b32 v15, 0
  v_mov_b32 v16, 0
  v_mov_b32 v17, 0
  v_mov_b32 v18, 0
  v_mov_b32 v19, 0
  v_mov_b32 v20, 0
  v_mov_b32 v21, 0
  v_mov_b32 v22, 0
  v_mov_b32 v23, 0
  v_mov_b32 v24, 0
  v_mov_b32 v25, 0
  v_mov_b32 v26, 0
  v_mov_b32 v27, 0
  v_mov_b32 v28, 0
  v_mov_b32 v29, 0
  v_mov_b32 v30, 0
  v_mov_b32 v31, 0
  v_mov_b32 v32, 0
  v_mov_b32 v33, 0
  v_mov_b32 v34, 0
  v_mov_b32 v35, 0
  v_mov_b32 v36, 0
  v_mov_b32 v37, 0
  v_mov_b32 v38, 0
  v_mov_b32 v39, 0
  s_cmp_eq_u32 s55, 0
  s_cbranch_scc0 L_RROW_26
  v_lshlrev_b32 v2, 2, v1
  v_add_u32 v2, 161024, v2
  ds_write_b32 v2, v233
L_RROW_26:
  ds_read_b64_tr_b16 v[40:41], v200 offset:8
  ds_read_b64_tr_b16 v[42:43], v200 offset:0
  ds_read_b128 v[104:107], v201 offset:0
  ds_read_b64_tr_b16 v[44:45], v200 offset:520
  ds_read_b64_tr_b16 v[46:47], v200 offset:512
  ds_read_b128 v[108:111], v201 offset:512
  ds_read_b64_tr_b16 v[48:49], v200 offset:1032
  ds_read_b64_tr_b16 v[50:51], v200 offset:1024
  ds_read_b128 v[112:115], v201 offset:1024
  ds_read_b64_tr_b16 v[52:53], v200 offset:1544
  ds_read_b64_tr_b16 v[54:55], v200 offset:1536
  ds_read_b128 v[116:119], v201 offset:1536
  ds_read_b64_tr_b16 v[56:57], v200 offset:2056
  ds_read_b64_tr_b16 v[58:59], v200 offset:2048
  ds_read_b128 v[120:123], v201 offset:2048
  ds_read_b64_tr_b16 v[60:61], v200 offset:2568
  ds_read_b64_tr_b16 v[62:63], v200 offset:2560
  ds_read_b128 v[124:127], v201 offset:2560
  ds_read_b64_tr_b16 v[64:65], v200 offset:3080
  ds_read_b64_tr_b16 v[66:67], v200 offset:3072
  ds_read_b128 v[128:131], v201 offset:3072
  ds_read_b64_tr_b16 v[68:69], v200 offset:3592
  ds_read_b64_tr_b16 v[70:71], v200 offset:3584
  ds_read_b128 v[132:135], v201 offset:3584
  v_lshrrev_b32 v2, 3, v0
  v_and_b32 v3, 7, v0
  v_lshlrev_b32 v245, 10, v2
  v_lshlrev_b32 v5, 4, v3
  v_add_u32 v245, v245, v5
  s_lshl_b32 s47, s37, 16
  s_lshl_b32 s46, s38, 7
  s_add_u32 s47, s47, s46
  buffer_load_dwordx4 v[246:249], v245, s[4:7], s47 offen
  s_waitcnt lgkmcnt(0)
  v_add_u32 v200, 64, v200
  v_subrev_u32 v201, 64, v201
  v_mfma_f32_16x16x32_bf16 v[8:11], v[40:43], v[104:107], v[8:11]
  ds_read_b64_tr_b16 v[72:73], v200 offset:8
  v_mfma_f32_16x16x32_bf16 v[12:15], v[40:43], v[108:111], v[12:15]
  ds_read_b64_tr_b16 v[74:75], v200 offset:0
  v_mfma_f32_16x16x32_bf16 v[16:19], v[40:43], v[112:115], v[16:19]
  ds_read_b128 v[136:139], v201 offset:0
  v_mfma_f32_16x16x32_bf16 v[20:23], v[40:43], v[116:119], v[20:23]
  ds_read_b64_tr_b16 v[76:77], v200 offset:520
  v_mfma_f32_16x16x32_bf16 v[24:27], v[40:43], v[120:123], v[24:27]
  ds_read_b64_tr_b16 v[78:79], v200 offset:512
  v_mfma_f32_16x16x32_bf16 v[28:31], v[40:43], v[124:127], v[28:31]
  ds_read_b128 v[140:143], v201 offset:512
  v_mfma_f32_16x16x32_bf16 v[32:35], v[40:43], v[128:131], v[32:35]
  ds_read_b64_tr_b16 v[80:81], v200 offset:1032
  v_mfma_f32_16x16x32_bf16 v[36:39], v[40:43], v[132:135], v[36:39]
  ds_read_b64_tr_b16 v[82:83], v200 offset:1024
  v_mfma_f32_16x16x32_bf16 v[12:15], v[44:47], v[104:107], v[12:15]
  ds_read_b128 v[144:147], v201 offset:1024
  v_mfma_f32_16x16x32_bf16 v[16:19], v[44:47], v[108:111], v[16:19]
  ds_read_b64_tr_b16 v[84:85], v200 offset:1544
  v_mfma_f32_16x16x32_bf16 v[20:23], v[44:47], v[112:115], v[20:23]
  ds_read_b64_tr_b16 v[86:87], v200 offset:1536
  v_mfma_f32_16x16x32_bf16 v[24:27], v[44:47], v[116:119], v[24:27]
  ds_read_b128 v[148:151], v201 offset:1536
  v_mfma_f32_16x16x32_bf16 v[28:31], v[44:47], v[120:123], v[28:31]
  ds_read_b64_tr_b16 v[88:89], v200 offset:2056
  v_mfma_f32_16x16x32_bf16 v[32:35], v[44:47], v[124:127], v[32:35]
  ds_read_b64_tr_b16 v[90:91], v200 offset:2048
  v_mfma_f32_16x16x32_bf16 v[36:39], v[44:47], v[128:131], v[36:39]
  ds_read_b128 v[152:155], v201 offset:2048
  v_mfma_f32_16x16x32_bf16 v[16:19], v[48:51], v[104:107], v[16:19]
  ds_read_b64_tr_b16 v[92:93], v200 offset:2568
  v_mfma_f32_16x16x32_bf16 v[20:23], v[48:51], v[108:111], v[20:23]
  ds_read_b64_tr_b16 v[94:95], v200 offset:2560
  v_mfma_f32_16x16x32_bf16 v[24:27], v[48:51], v[112:115], v[24:27]
  ds_read_b128 v[156:159], v201 offset:2560
  v_mfma_f32_16x16x32_bf16 v[28:31], v[48:51], v[116:119], v[28:31]
  ds_read_b64_tr_b16 v[96:97], v200 offset:3080
  v_mfma_f32_16x16x32_bf16 v[32:35], v[48:51], v[120:123], v[32:35]
  ds_read_b64_tr_b16 v[98:99], v200 offset:3072
  v_mfma_f32_16x16x32_bf16 v[36:39], v[48:51], v[124:127], v[36:39]
  ds_read_b128 v[160:163], v201 offset:3072
  v_mfma_f32_16x16x32_bf16 v[20:23], v[52:55], v[104:107], v[20:23]
  ds_read_b64_tr_b16 v[100:101], v200 offset:3592
  v_mfma_f32_16x16x32_bf16 v[24:27], v[52:55], v[108:111], v[24:27]
  ds_read_b64_tr_b16 v[102:103], v200 offset:3584
  v_mfma_f32_16x16x32_bf16 v[28:31], v[52:55], v[112:115], v[28:31]
  ds_read_b128 v[164:167], v201 offset:3584
  v_mfma_f32_16x16x32_bf16 v[32:35], v[52:55], v[116:119], v[32:35]
  v_mfma_f32_16x16x32_bf16 v[36:39], v[52:55], v[120:123], v[36:39]
  v_mfma_f32_16x16x32_bf16 v[24:27], v[56:59], v[104:107], v[24:27]
  v_mfma_f32_16x16x32_bf16 v[28:31], v[56:59], v[108:111], v[28:31]
  v_mfma_f32_16x16x32_bf16 v[32:35], v[56:59], v[112:115], v[32:35]
  v_mfma_f32_16x16x32_bf16 v[36:39], v[56:59], v[116:119], v[36:39]
  v_mfma_f32_16x16x32_bf16 v[28:31], v[60:63], v[104:107], v[28:31]
  v_mfma_f32_16x16x32_bf16 v[32:35], v[60:63], v[108:111], v[32:35]
  v_mfma_f32_16x16x32_bf16 v[36:39], v[60:63], v[112:115], v[36:39]
  v_mfma_f32_16x16x32_bf16 v[32:35], v[64:67], v[104:107], v[32:35]
  v_mfma_f32_16x16x32_bf16 v[36:39], v[64:67], v[108:111], v[36:39]
  v_mfma_f32_16x16x32_bf16 v[36:39], v[68:71], v[104:107], v[36:39]
  s_waitcnt lgkmcnt(0)
  v_add_u32 v200, 64, v200
  v_subrev_u32 v201, 64, v201
  v_mfma_f32_16x16x32_bf16 v[8:11], v[72:75], v[136:139], v[8:11]
  ds_read_b64_tr_b16 v[40:41], v200 offset:8
  v_mfma_f32_16x16x32_bf16 v[12:15], v[72:75], v[140:143], v[12:15]
  ds_read_b64_tr_b16 v[42:43], v200 offset:0
  v_mfma_f32_16x16x32_bf16 v[16:19], v[72:75], v[144:147], v[16:19]
  ds_read_b128 v[104:107], v201 offset:0
  v_mfma_f32_16x16x32_bf16 v[20:23], v[72:75], v[148:151], v[20:23]
  ds_read_b64_tr_b16 v[44:45], v200 offset:520
  v_mfma_f32_16x16x32_bf16 v[24:27], v[72:75], v[152:155], v[24:27]
  ds_read_b64_tr_b16 v[46:47], v200 offset:512
  v_mfma_f32_16x16x32_bf16 v[28:31], v[72:75], v[156:159], v[28:31]
  ds_read_b128 v[108:111], v201 offset:512
  v_mfma_f32_16x16x32_bf16 v[32:35], v[72:75], v[160:163], v[32:35]
  ds_read_b64_tr_b16 v[48:49], v200 offset:1032
  v_mfma_f32_16x16x32_bf16 v[36:39], v[72:75], v[164:167], v[36:39]
  ds_read_b64_tr_b16 v[50:51], v200 offset:1024
  v_mfma_f32_16x16x32_bf16 v[12:15], v[76:79], v[136:139], v[12:15]
  ds_read_b128 v[112:115], v201 offset:1024
  v_mfma_f32_16x16x32_bf16 v[16:19], v[76:79], v[140:143], v[16:19]
  ds_read_b64_tr_b16 v[52:53], v200 offset:1544
  v_mfma_f32_16x16x32_bf16 v[20:23], v[76:79], v[144:147], v[20:23]
  ds_read_b64_tr_b16 v[54:55], v200 offset:1536
  v_mfma_f32_16x16x32_bf16 v[24:27], v[76:79], v[148:151], v[24:27]
  ds_read_b128 v[116:119], v201 offset:1536
  v_mfma_f32_16x16x32_bf16 v[28:31], v[76:79], v[152:155], v[28:31]
  ds_read_b64_tr_b16 v[56:57], v200 offset:2056
  v_mfma_f32_16x16x32_bf16 v[32:35], v[76:79], v[156:159], v[32:35]
  ds_read_b64_tr_b16 v[58:59], v200 offset:2048
  v_mfma_f32_16x16x32_bf16 v[36:39], v[76:79], v[160:163], v[36:39]
  ds_read_b128 v[120:123], v201 offset:2048
  v_mfma_f32_16x16x32_bf16 v[16:19], v[80:83], v[136:139], v[16:19]
  ds_read_b64_tr_b16 v[60:61], v200 offset:2568
  v_mfma_f32_16x16x32_bf16 v[20:23], v[80:83], v[140:143], v[20:23]
  ds_read_b64_tr_b16 v[62:63], v200 offset:2560
  v_mfma_f32_16x16x32_bf16 v[24:27], v[80:83], v[144:147], v[24:27]
  ds_read_b128 v[124:127], v201 offset:2560
  v_mfma_f32_16x16x32_bf16 v[28:31], v[80:83], v[148:151], v[28:31]
  ds_read_b64_tr_b16 v[64:65], v200 offset:3080
  v_mfma_f32_16x16x32_bf16 v[32:35], v[80:83], v[152:155], v[32:35]
  ds_read_b64_tr_b16 v[66:67], v200 offset:3072
  v_mfma_f32_16x16x32_bf16 v[36:39], v[80:83], v[156:159], v[36:39]
  ds_read_b128 v[128:131], v201 offset:3072
  v_mfma_f32_16x16x32_bf16 v[20:23], v[84:87], v[136:139], v[20:23]
  ds_read_b64_tr_b16 v[68:69], v200 offset:3592
  v_mfma_f32_16x16x32_bf16 v[24:27], v[84:87], v[140:143], v[24:27]
  ds_read_b64_tr_b16 v[70:71], v200 offset:3584
  v_mfma_f32_16x16x32_bf16 v[28:31], v[84:87], v[144:147], v[28:31]
  ds_read_b128 v[132:135], v201 offset:3584
  v_mfma_f32_16x16x32_bf16 v[32:35], v[84:87], v[148:151], v[32:35]
  v_mfma_f32_16x16x32_bf16 v[36:39], v[84:87], v[152:155], v[36:39]
  v_mfma_f32_16x16x32_bf16 v[24:27], v[88:91], v[136:139], v[24:27]
  v_mfma_f32_16x16x32_bf16 v[28:31], v[88:91], v[140:143], v[28:31]
  v_mfma_f32_16x16x32_bf16 v[32:35], v[88:91], v[144:147], v[32:35]
  v_mfma_f32_16x16x32_bf16 v[36:39], v[88:91], v[148:151], v[36:39]
  v_mfma_f32_16x16x32_bf16 v[28:31], v[92:95], v[136:139], v[28:31]
  v_mfma_f32_16x16x32_bf16 v[32:35], v[92:95], v[140:143], v[32:35]
  v_mfma_f32_16x16x32_bf16 v[36:39], v[92:95], v[144:147], v[36:39]
  v_mfma_f32_16x16x32_bf16 v[32:35], v[96:99], v[136:139], v[32:35]
  v_mfma_f32_16x16x32_bf16 v[36:39], v[96:99], v[140:143], v[36:39]
  v_mfma_f32_16x16x32_bf16 v[36:39], v[100:103], v[136:139], v[36:39]
  s_waitcnt lgkmcnt(0)
  v_add_u32 v200, 64, v200
  v_subrev_u32 v201, 64, v201
  v_mfma_f32_16x16x32_bf16 v[8:11], v[40:43], v[104:107], v[8:11]
  ds_read_b64_tr_b16 v[72:73], v200 offset:8
  v_mfma_f32_16x16x32_bf16 v[12:15], v[40:43], v[108:111], v[12:15]
  ds_read_b64_tr_b16 v[74:75], v200 offset:0
  v_mfma_f32_16x16x32_bf16 v[16:19], v[40:43], v[112:115], v[16:19]
  ds_read_b128 v[136:139], v201 offset:0
  v_mfma_f32_16x16x32_bf16 v[20:23], v[40:43], v[116:119], v[20:23]
  ds_read_b64_tr_b16 v[76:77], v200 offset:520
  v_mfma_f32_16x16x32_bf16 v[24:27], v[40:43], v[120:123], v[24:27]
  ds_read_b64_tr_b16 v[78:79], v200 offset:512
  v_mfma_f32_16x16x32_bf16 v[28:31], v[40:43], v[124:127], v[28:31]
  ds_read_b128 v[140:143], v201 offset:512
  v_mfma_f32_16x16x32_bf16 v[32:35], v[40:43], v[128:131], v[32:35]
  ds_read_b64_tr_b16 v[80:81], v200 offset:1032
  v_mfma_f32_16x16x32_bf16 v[36:39], v[40:43], v[132:135], v[36:39]
  ds_read_b64_tr_b16 v[82:83], v200 offset:1024
  v_mfma_f32_16x16x32_bf16 v[12:15], v[44:47], v[104:107], v[12:15]
  ds_read_b128 v[144:147], v201 offset:1024
  v_mfma_f32_16x16x32_bf16 v[16:19], v[44:47], v[108:111], v[16:19]
  ds_read_b64_tr_b16 v[84:85], v200 offset:1544
  v_mfma_f32_16x16x32_bf16 v[20:23], v[44:47], v[112:115], v[20:23]
  ds_read_b64_tr_b16 v[86:87], v200 offset:1536
  v_mfma_f32_16x16x32_bf16 v[24:27], v[44:47], v[116:119], v[24:27]
  ds_read_b128 v[148:151], v201 offset:1536
  v_mfma_f32_16x16x32_bf16 v[28:31], v[44:47], v[120:123], v[28:31]
  ds_read_b64_tr_b16 v[88:89], v200 offset:2056
  v_mfma_f32_16x16x32_bf16 v[32:35], v[44:47], v[124:127], v[32:35]
  ds_read_b64_tr_b16 v[90:91], v200 offset:2048
  v_mfma_f32_16x16x32_bf16 v[36:39], v[44:47], v[128:131], v[36:39]
  ds_read_b128 v[152:155], v201 offset:2048
  v_mfma_f32_16x16x32_bf16 v[16:19], v[48:51], v[104:107], v[16:19]
  ds_read_b64_tr_b16 v[92:93], v200 offset:2568
  v_mfma_f32_16x16x32_bf16 v[20:23], v[48:51], v[108:111], v[20:23]
  ds_read_b64_tr_b16 v[94:95], v200 offset:2560
  v_mfma_f32_16x16x32_bf16 v[24:27], v[48:51], v[112:115], v[24:27]
  ds_read_b128 v[156:159], v201 offset:2560
  v_mfma_f32_16x16x32_bf16 v[28:31], v[48:51], v[116:119], v[28:31]
  ds_read_b64_tr_b16 v[96:97], v200 offset:3080
  v_mfma_f32_16x16x32_bf16 v[32:35], v[48:51], v[120:123], v[32:35]
  ds_read_b64_tr_b16 v[98:99], v200 offset:3072
  v_mfma_f32_16x16x32_bf16 v[36:39], v[48:51], v[124:127], v[36:39]
  ds_read_b128 v[160:163], v201 offset:3072
  v_mfma_f32_16x16x32_bf16 v[20:23], v[52:55], v[104:107], v[20:23]
  ds_read_b64_tr_b16 v[100:101], v200 offset:3592
  v_mfma_f32_16x16x32_bf16 v[24:27], v[52:55], v[108:111], v[24:27]
  ds_read_b64_tr_b16 v[102:103], v200 offset:3584
  v_mfma_f32_16x16x32_bf16 v[28:31], v[52:55], v[112:115], v[28:31]
  ds_read_b128 v[164:167], v201 offset:3584
  v_mfma_f32_16x16x32_bf16 v[32:35], v[52:55], v[116:119], v[32:35]
  v_mfma_f32_16x16x32_bf16 v[36:39], v[52:55], v[120:123], v[36:39]
  v_mfma_f32_16x16x32_bf16 v[24:27], v[56:59], v[104:107], v[24:27]
  v_mfma_f32_16x16x32_bf16 v[28:31], v[56:59], v[108:111], v[28:31]
  v_mfma_f32_16x16x32_bf16 v[32:35], v[56:59], v[112:115], v[32:35]
  v_mfma_f32_16x16x32_bf16 v[36:39], v[56:59], v[116:119], v[36:39]
  v_mfma_f32_16x16x32_bf16 v[28:31], v[60:63], v[104:107], v[28:31]
  v_mfma_f32_16x16x32_bf16 v[32:35], v[60:63], v[108:111], v[32:35]
  v_mfma_f32_16x16x32_bf16 v[36:39], v[60:63], v[112:115], v[36:39]
  v_mfma_f32_16x16x32_bf16 v[32:35], v[64:67], v[104:107], v[32:35]
  v_mfma_f32_16x16x32_bf16 v[36:39], v[64:67], v[108:111], v[36:39]
  v_mfma_f32_16x16x32_bf16 v[36:39], v[68:71], v[104:107], v[36:39]
  s_waitcnt lgkmcnt(0)
  v_mfma_f32_16x16x32_bf16 v[8:11], v[72:75], v[136:139], v[8:11]
  v_mfma_f32_16x16x32_bf16 v[12:15], v[72:75], v[140:143], v[12:15]
  v_mfma_f32_16x16x32_bf16 v[16:19], v[72:75], v[144:147], v[16:19]
  v_mfma_f32_16x16x32_bf16 v[20:23], v[72:75], v[148:151], v[20:23]
  v_mfma_f32_16x16x32_bf16 v[24:27], v[72:75], v[152:155], v[24:27]
  v_mfma_f32_16x16x32_bf16 v[28:31], v[72:75], v[156:159], v[28:31]
  v_mfma_f32_16x16x32_bf16 v[32:35], v[72:75], v[160:163], v[32:35]
  v_mfma_f32_16x16x32_bf16 v[36:39], v[72:75], v[164:167], v[36:39]
  v_mfma_f32_16x16x32_bf16 v[12:15], v[76:79], v[136:139], v[12:15]
  v_mfma_f32_16x16x32_bf16 v[16:19], v[76:79], v[140:143], v[16:19]
  v_mfma_f32_16x16x32_bf16 v[20:23], v[76:79], v[144:147], v[20:23]
  v_mfma_f32_16x16x32_bf16 v[24:27], v[76:79], v[148:151], v[24:27]
  v_mfma_f32_16x16x32_bf16 v[28:31], v[76:79], v[152:155], v[28:31]
  v_mfma_f32_16x16x32_bf16 v[32:35], v[76:79], v[156:159], v[32:35]
  v_mfma_f32_16x16x32_bf16 v[36:39], v[76:79], v[160:163], v[36:39]
  v_mfma_f32_16x16x32_bf16 v[16:19], v[80:83], v[136:139], v[16:19]
  v_mfma_f32_16x16x32_bf16 v[20:23], v[80:83], v[140:143], v[20:23]
  v_mfma_f32_16x16x32_bf16 v[24:27], v[80:83], v[144:147], v[24:27]
  v_mfma_f32_16x16x32_bf16 v[28:31], v[80:83], v[148:151], v[28:31]
  v_mfma_f32_16x16x32_bf16 v[32:35], v[80:83], v[152:155], v[32:35]
  v_mfma_f32_16x16x32_bf16 v[36:39], v[80:83], v[156:159], v[36:39]
  v_mfma_f32_16x16x32_bf16 v[20:23], v[84:87], v[136:139], v[20:23]
  v_mfma_f32_16x16x32_bf16 v[24:27], v[84:87], v[140:143], v[24:27]
  v_mfma_f32_16x16x32_bf16 v[28:31], v[84:87], v[144:147], v[28:31]
  v_mfma_f32_16x16x32_bf16 v[32:35], v[84:87], v[148:151], v[32:35]
  v_mfma_f32_16x16x32_bf16 v[36:39], v[84:87], v[152:155], v[36:39]
  v_mfma_f32_16x16x32_bf16 v[24:27], v[88:91], v[136:139], v[24:27]
  v_mfma_f32_16x16x32_bf16 v[28:31], v[88:91], v[140:143], v[28:31]
  v_mfma_f32_16x16x32_bf16 v[32:35], v[88:91], v[144:147], v[32:35]
  v_mfma_f32_16x16x32_bf16 v[36:39], v[88:91], v[148:151], v[36:39]
  v_mfma_f32_16x16x32_bf16 v[28:31], v[92:95], v[136:139], v[28:31]
  v_mfma_f32_16x16x32_bf16 v[32:35], v[92:95], v[140:143], v[32:35]
  v_mfma_f32_16x16x32_bf16 v[36:39], v[92:95], v[144:147], v[36:39]
  v_mfma_f32_16x16x32_bf16 v[32:35], v[96:99], v[136:139], v[32:35]
  v_mfma_f32_16x16x32_bf16 v[36:39], v[96:99], v[140:143], v[36:39]
  v_mfma_f32_16x16x32_bf16 v[36:39], v[100:103], v[136:139], v[36:39]
  s_nop 7
  s_lshl_b32 s42, s55, 12
  s_add_u32 s42, s42, 82432
  v_lshlrev_b32 v2, 4, v1
  v_add_u32 v3, s42, v2
  s_xor_b32 s43, s55, 1
  s_lshl_b32 s43, s43, 12
  s_add_u32 s43, s43, 82432
  v_add_u32 v4, s43, v2
  s_cmp_eq_u32 s41, 1
  s_cbranch_scc1 L_CX1
  ds_write_b128 v3, v[24:27] offset:0
  ds_write_b128 v3, v[28:31] offset:1024
  ds_write_b128 v3, v[32:35] offset:2048
  ds_write_b128 v3, v[36:39] offset:3072
  s_branch L_CX2
L_CX1:
  ds_write_b128 v3, v[8:11] offset:0
  ds_write_b128 v3, v[12:15] offset:1024
  ds_write_b128 v3, v[16:19] offset:2048
  ds_write_b128 v3, v[20:23] offset:3072
  v_mov_b32 v8, v24
  v_mov_b32 v9, v25
  v_mov_b32 v10, v26
  v_mov_b32 v11, v27
  v_mov_b32 v12, v28
  v_mov_b32 v13, v29
  v_mov_b32 v14, v30
  v_mov_b32 v15, v31
  v_mov_b32 v16, v32
  v_mov_b32 v17, v33
  v_mov_b32 v18, v34
  v_mov_b32 v19, v35
  v_mov_b32 v20, v36
  v_mov_b32 v21, v37
  v_mov_b32 v22, v38
  v_mov_b32 v23, v39
L_CX2:
  s_waitcnt lgkmcnt(0)
  s_lshl_b32 s42, s55, 2
  s_add_u32 s42, s42, 160912
  v_mov_b32 v5, s42
  v_mov_b32 v6, 1
  ds_write_b32 v5, v6
  s_xor_b32 s43, s55, 1
  s_lshl_b32 s43, s43, 2
  s_add_u32 s43, s43, 160912
  v_mov_b32 v5, s43
  s_mov_b32 s57, 0
L_CXW:
  ds_read_b32 v6, v5
  s_waitcnt lgkmcnt(0)
  v_readfirstlane_b32 s44, v6
  s_add_u32 s57, s57, 1
  s_cmp_gt_u32 s57, 1000000
  s_cbranch_scc1 L_CXD
  s_cmp_eq_u32 s44, 0
  s_cbranch_scc1 L_CXW
L_CXD:
  ds_read_b128 v[40:43], v4 offset:0
  ds_read_b128 v[44:47], v4 offset:1024
  ds_read_b128 v[48:51], v4 offset:2048
  ds_read_b128 v[52:55], v4 offset:3072
  v_and_b32 v6, 15, v1
  v_lshlrev_b32 v6, 5, v6
  v_lshrrev_b32 v7, 4, v1
  v_lshlrev_b32 v7, 3, v7
  v_add_u32 v6, v6, v7
  s_mul_i32 s42, s40, 4608
  s_lshl_b32 s43, s41, 11
  s_add_u32 s42, s42, s43
  s_add_u32 s42, s42, 148736
  v_add_u32 v7, s42, v6
  ds_read_b64 v[56:57], v7 offset:0
  ds_read_b64 v[58:59], v7 offset:512
  ds_read_b64 v[60:61], v7 offset:1024
  ds_read_b64 v[62:63], v7 offset:1536
  s_lshl_b32 s45, s36, 2
  s_load_dword s61, s[76:77], s45
  s_waitcnt lgkmcnt(0)
  s_lshl_b32 s42, s61, 16
  s_and_b32 s43, s61, 0xffff0000
  s_cmp_eq_u32 s40, 0
  s_cselect_b32 s46, s42, s43
  s_lshl_b32 s42, s36, 1
  s_add_u32 s42, s42, s40
  s_lshl_b32 s42, s42, 12
  s_lshl_b32 s43, s41, 11
  s_add_u32 s42, s42, s43
  s_add_u32 s42, s42, 10485760
  v_add_f32 v8, v8, v40
  v_add_f32 v9, v9, v41
  v_add_f32 v10, v10, v42
  v_add_f32 v11, v11, v43
  v_cvt_pk_bf16_f32 v64, v8, v9
  v_cvt_pk_bf16_f32 v65, v10, v11
  v_lshlrev_b32 v66, 16, v56
  v_and_b32 v67, 0xffff0000, v56
  v_lshlrev_b32 v68, 16, v57
  v_and_b32 v69, 0xffff0000, v57
  v_mul_f32 v66, s46, v66
  v_mul_f32 v67, s46, v67
  v_mul_f32 v68, s46, v68
  v_mul_f32 v69, s46, v69
  v_cvt_pk_bf16_f32 v70, v66, v67
  v_cvt_pk_bf16_f32 v71, v68, v69
  v_lshlrev_b32 v66, 16, v64
  v_and_b32 v67, 0xffff0000, v64
  v_lshlrev_b32 v68, 16, v65
  v_and_b32 v69, 0xffff0000, v65
  v_lshlrev_b32 v72, 16, v70
  v_and_b32 v73, 0xffff0000, v70
  v_lshlrev_b32 v74, 16, v71
  v_and_b32 v75, 0xffff0000, v71
  v_add_f32 v66, v66, v72
  v_add_f32 v67, v67, v73
  v_add_f32 v68, v68, v74
  v_add_f32 v69, v69, v75
  v_cvt_pk_bf16_f32 v76, v66, v67
  v_cvt_pk_bf16_f32 v77, v68, v69
  buffer_store_dwordx2 v[76:77], v6, s[16:19], s42 offen offset:0 sc1
  v_add_f32 v12, v12, v44
  v_add_f32 v13, v13, v45
  v_add_f32 v14, v14, v46
  v_add_f32 v15, v15, v47
  v_cvt_pk_bf16_f32 v64, v12, v13
  v_cvt_pk_bf16_f32 v65, v14, v15
  v_lshlrev_b32 v66, 16, v58
  v_and_b32 v67, 0xffff0000, v58
  v_lshlrev_b32 v68, 16, v59
  v_and_b32 v69, 0xffff0000, v59
  v_mul_f32 v66, s46, v66
  v_mul_f32 v67, s46, v67
  v_mul_f32 v68, s46, v68
  v_mul_f32 v69, s46, v69
  v_cvt_pk_bf16_f32 v70, v66, v67
  v_cvt_pk_bf16_f32 v71, v68, v69
  v_lshlrev_b32 v66, 16, v64
  v_and_b32 v67, 0xffff0000, v64
  v_lshlrev_b32 v68, 16, v65
  v_and_b32 v69, 0xffff0000, v65
  v_lshlrev_b32 v72, 16, v70
  v_and_b32 v73, 0xffff0000, v70
  v_lshlrev_b32 v74, 16, v71
  v_and_b32 v75, 0xffff0000, v71
  v_add_f32 v66, v66, v72
  v_add_f32 v67, v67, v73
  v_add_f32 v68, v68, v74
  v_add_f32 v69, v69, v75
  v_cvt_pk_bf16_f32 v78, v66, v67
  v_cvt_pk_bf16_f32 v79, v68, v69
  buffer_store_dwordx2 v[78:79], v6, s[16:19], s42 offen offset:512 sc1
  v_add_f32 v16, v16, v48
  v_add_f32 v17, v17, v49
  v_add_f32 v18, v18, v50
  v_add_f32 v19, v19, v51
  v_cvt_pk_bf16_f32 v64, v16, v17
  v_cvt_pk_bf16_f32 v65, v18, v19
  v_lshlrev_b32 v66, 16, v60
  v_and_b32 v67, 0xffff0000, v60
  v_lshlrev_b32 v68, 16, v61
  v_and_b32 v69, 0xffff0000, v61
  v_mul_f32 v66, s46, v66
  v_mul_f32 v67, s46, v67
  v_mul_f32 v68, s46, v68
  v_mul_f32 v69, s46, v69
  v_cvt_pk_bf16_f32 v70, v66, v67
  v_cvt_pk_bf16_f32 v71, v68, v69
  v_lshlrev_b32 v66, 16, v64
  v_and_b32 v67, 0xffff0000, v64
  v_lshlrev_b32 v68, 16, v65
  v_and_b32 v69, 0xffff0000, v65
  v_lshlrev_b32 v72, 16, v70
  v_and_b32 v73, 0xffff0000, v70
  v_lshlrev_b32 v74, 16, v71
  v_and_b32 v75, 0xffff0000, v71
  v_add_f32 v66, v66, v72
  v_add_f32 v67, v67, v73
  v_add_f32 v68, v68, v74
  v_add_f32 v69, v69, v75
  v_cvt_pk_bf16_f32 v76, v66, v67
  v_cvt_pk_bf16_f32 v77, v68, v69
  buffer_store_dwordx2 v[76:77], v6, s[16:19], s42 offen offset:1024 sc1
  v_add_f32 v20, v20, v52
  v_add_f32 v21, v21, v53
  v_add_f32 v22, v22, v54
  v_add_f32 v23, v23, v55
  v_cvt_pk_bf16_f32 v64, v20, v21
  v_cvt_pk_bf16_f32 v65, v22, v23
  v_lshlrev_b32 v66, 16, v62
  v_and_b32 v67, 0xffff0000, v62
  v_lshlrev_b32 v68, 16, v63
  v_and_b32 v69, 0xffff0000, v63
  v_mul_f32 v66, s46, v66
  v_mul_f32 v67, s46, v67
  v_mul_f32 v68, s46, v68
  v_mul_f32 v69, s46, v69
  v_cvt_pk_bf16_f32 v70, v66, v67
  v_cvt_pk_bf16_f32 v71, v68, v69
  v_lshlrev_b32 v66, 16, v64
  v_and_b32 v67, 0xffff0000, v64
  v_lshlrev_b32 v68, 16, v65
  v_and_b32 v69, 0xffff0000, v65
  v_lshlrev_b32 v72, 16, v70
  v_and_b32 v73, 0xffff0000, v70
  v_lshlrev_b32 v74, 16, v71
  v_and_b32 v75, 0xffff0000, v71
  v_add_f32 v66, v66, v72
  v_add_f32 v67, v67, v73
  v_add_f32 v68, v68, v74
  v_add_f32 v69, v69, v75
  v_cvt_pk_bf16_f32 v78, v66, v67
  v_cvt_pk_bf16_f32 v79, v68, v69
  buffer_store_dwordx2 v[78:79], v6, s[16:19], s42 offen offset:1536 sc1
  s_waitcnt vmcnt(0)
  s_lshr_b32 s42, s36, 5
  s_lshl_b32 s42, s42, 9
  s_and_b32 s43, s36, 31
  s_lshl_b32 s43, s43, 4
  s_add_u32 s42, s42, s43
  s_lshl_b32 s43, s55, 2
  s_add_u32 s42, s42, s43
  s_add_u32 s42, s42, 12693504
  s_mov_b64 exec, 1
  v_mov_b32 v250, s63
  v_mov_b32 v251, 0
  buffer_store_dword v250, v251, s[16:19], s42 offen sc1
  s_cmp_eq_u32 s2, 0
  s_cbranch_scc0 L_NOEP_27
  s_cmp_eq_u32 s55, 0
  s_cbranch_scc0 L_NOEP_27
  s_mov_b32 s42, 12701696
  v_mov_b32 v250, s63
  v_mov_b32 v251, 0
  buffer_store_dword v250, v251, s[16:19], s42 offen sc1
L_NOEP_27:
  s_mov_b64 exec, -1
  s_cmp_eq_u32 s55, 0
  s_cbranch_scc0 L_F4W_28
  s_lshl_b32 s44, s38, 9
  s_add_u32 s44, s44, 12693504
  s_sleep 8
  v_lshlrev_b32 v4, 3, v1
  s_mov_b32 s57, 0
L_PF_30:
  buffer_load_dwordx2 v[2:3], v4, s[16:19], s44 offen sc1
  s_waitcnt vmcnt(0)
  v_cmp_ne_u32 vcc, s63, v2
  v_cmp_ne_u32 s[40:41], s63, v3
  s_or_b64 vcc, vcc, s[40:41]
  s_add_u32 s57, s57, 1
  s_cmp_eq_u64 vcc, 0
  s_cbranch_scc1 L_PFD_31
  s_cmp_gt_u32 s57, 100000
  s_cbranch_scc1 L_PFD_31
  s_sleep 16
  s_branch L_PF_30
L_PFD_31:
  s_waitcnt lgkmcnt(0)
  v_mov_b32 v2, 160956
  v_mov_b32 v3, 1
  ds_write_b32 v2, v3
  s_branch L_F4D_29
L_F4W_28:
  v_mov_b32 v2, 160956
  s_mov_b32 s57, 0
L_LW_32:
  ds_read_b32 v4, v2
  s_waitcnt lgkmcnt(0)
  s_add_u32 s57, s57, 1
  v_readfirstlane_b32 s40, v4
  s_cmp_gt_u32 s57, 1000000
  s_cbranch_scc1 L_LWD_33
  s_cmp_eq_u32 s40, 0
  s_cbranch_scc0 L_LWD_33
  s_sleep 1
  s_branch L_LW_32
L_LWD_33:
L_F4D_29:
  v_lshrrev_b32 v2, 3, v1
  v_lshlrev_b32 v3, 12, v2
  v_and_b32 v4, 7, v1
  v_lshlrev_b32 v4, 4, v4
  v_add_u32 v3, v3, v4
  s_lshl_b32 s42, s38, 6
  s_lshl_b32 s43, s55, 4
  s_add_u32 s42, s42, s43
  s_lshl_b32 s42, s42, 12
  s_lshl_b32 s43, s37, 7
  s_add_u32 s42, s42, s43
  s_add_u32 s42, s42, 10485760
  buffer_load_dwordx4 v[8:11], v3, s[16:19], s42 offen sc1
  s_add_u32 s42, s42, 32768
  buffer_load_dwordx4 v[12:15], v3, s[16:19], s42 offen sc1
  v_mul_u32_u24 v2, 132, v2
  v_add_u32 v2, v2, v4
  s_mul_i32 s42, s55, 2112
  s_add_u32 s42, s42, 98816
  v_add_u32 v2, s42, v2
  s_waitcnt vmcnt(0)
  ds_write_b32 v2, v8 offset:0
  ds_write_b32 v2, v12 offset:1056
  ds_write_b32 v2, v9 offset:4
  ds_write_b32 v2, v13 offset:1060
  ds_write_b32 v2, v10 offset:8
  ds_write_b32 v2, v14 offset:1064
  ds_write_b32 v2, v11 offset:12
  ds_write_b32 v2, v15 offset:1068
  s_waitcnt lgkmcnt(0)
  s_branch L_P_F
L_P_G2:
  s_setprio 1
  s_mov_b32 s48, s3
  s_mul_i32 s49, s48, 22
  s_cmp_eq_u32 s48, 3
  s_cselect_b32 s42, 1, 0
  s_sub_u32 s49, s49, s42
  s_cmp_ge_u32 s48, 2
  s_cselect_b32 s53, 21, 22
  s_mul_i32 s54, s38, 3
  s_and_b32 s42, s37, 3
  s_mul_i32 s42, s42, 5
  s_add_u32 s54, s54, s42
  s_cmp_ge_u32 s54, s53
  s_cselect_b32 s42, s53, 0
  s_sub_u32 s54, s54, s42
  s_cmp_ge_u32 s54, s53
  s_cselect_b32 s42, s53, 0
  s_sub_u32 s54, s54, s42
  s_and_b32 s50, s48, 1
  s_mul_i32 s50, s50, 20480
  s_cmp_ge_u32 s48, 2
  s_cselect_b32 s42, 107264, 0
  s_add_u32 s50, s50, s42
  s_lshl_b32 s51, s38, 7
  s_lshl_b32 s58, s49, 14
  s_add_u32 s58, s58, s51
  s_lshl_b32 s59, s53, 14
  s_add_u32 s59, s59, s58
  s_lshl_b32 s56, s54, 14
  s_add_u32 s56, s56, s58
  s_mov_b32 s28, s84
  s_and_b32 s29, s85, 0xffff
  s_mov_b32 s30, 1409024
  s_mov_b32 s31, 0x20000
  v_lshrrev_b32 v2, 3, v1
  v_and_b32 v3, 7, v1
  v_lshrrev_b32 v4, 1, v2
  v_and_b32 v4, 1, v4
  v_lshlrev_b32 v4, 2, v4
  v_xor_b32 v3, v3, v4
  v_lshlrev_b32 v3, 4, v3
  v_lshlrev_b32 v2, 10, v2
  v_add_u32 v240, v2, v3
  s_lshl_b32 s44, s32, 8
  s_lshl_b32 s43, s33, 4
  s_add_u32 s44, s44, s43
  s_lshl_b32 s43, s3, 2
  s_add_u32 s44, s44, s43
  s_add_u32 s44, s44, 12689408
  s_cmp_lt_u32 s48, 2
  s_cbranch_scc1 L_W01_36
  s_add_u32 m0, s50, 0
  s_add_u32 s42, s56, 8192
  buffer_load_dwordx4 v240, s[28:31], s56 offen lds
  s_add_u32 m0, s50, 1024
  s_nop 0
  buffer_load_dwordx4 v240, s[28:31], s42 offen lds
  s_add_u32 s56, s56, 16384
  s_cmp_eq_u32 s56, s59
  s_cselect_b32 s56, s58, s56
  s_add_u32 m0, s50, 2048
  s_add_u32 s42, s56, 8192
  buffer_load_dwordx4 v240, s[28:31], s56 offen lds
  s_add_u32 m0, s50, 3072
  s_nop 0
  buffer_load_dwordx4 v240, s[28:31], s42 offen lds
  s_add_u32 s56, s56, 16384
  s_cmp_eq_u32 s56, s59
  s_cselect_b32 s56, s58, s56
  s_add_u32 m0, s50, 4096
  s_add_u32 s42, s56, 8192
  buffer_load_dwordx4 v240, s[28:31], s56 offen lds
  s_add_u32 m0, s50, 5120
  s_nop 0
  buffer_load_dwordx4 v240, s[28:31], s42 offen lds
  s_add_u32 s56, s56, 16384
  s_cmp_eq_u32 s56, s59
  s_cselect_b32 s56, s58, s56
  s_add_u32 m0, s50, 6144
  s_add_u32 s42, s56, 8192
  buffer_load_dwordx4 v240, s[28:31], s56 offen lds
  s_add_u32 m0, s50, 7168
  s_nop 0
  buffer_load_dwordx4 v240, s[28:31], s42 offen lds
  s_add_u32 s56, s56, 16384
  s_cmp_eq_u32 s56, s59
  s_cselect_b32 s56, s58, s56
  s_add_u32 m0, s50, 8192
  s_add_u32 s42, s56, 8192
  buffer_load_dwordx4 v240, s[28:31], s56 offen lds
  s_add_u32 m0, s50, 9216
  s_nop 0
  buffer_load_dwordx4 v240, s[28:31], s42 offen lds
  s_add_u32 s56, s56, 16384
  s_cmp_eq_u32 s56, s59
  s_cselect_b32 s56, s58, s56
  s_add_u32 m0, s50, 10240
  s_add_u32 s42, s56, 8192
  buffer_load_dwordx4 v240, s[28:31], s56 offen lds
  s_add_u32 m0, s50, 11264
  s_nop 0
  buffer_load_dwordx4 v240, s[28:31], s42 offen lds
  s_add_u32 s56, s56, 16384
  s_cmp_eq_u32 s56, s59
  s_cselect_b32 s56, s58, s56
  s_add_u32 m0, s50, 12288
  s_add_u32 s42, s56, 8192
  buffer_load_dwordx4 v240, s[28:31], s56 offen lds
  s_add_u32 m0, s50, 13312
  s_nop 0
  buffer_load_dwordx4 v240, s[28:31], s42 offen lds
  s_add_u32 s56, s56, 16384
  s_cmp_eq_u32 s56, s59
  s_cselect_b32 s56, s58, s56
  s_add_u32 m0, s50, 14336
  s_add_u32 s42, s56, 8192
  buffer_load_dwordx4 v240, s[28:31], s56 offen lds
  s_add_u32 m0, s50, 15360
  s_nop 0
  buffer_load_dwordx4 v240, s[28:31], s42 offen lds
  s_add_u32 s56, s56, 16384
  s_cmp_eq_u32 s56, s59
  s_cselect_b32 s56, s58, s56
  s_add_u32 m0, s50, 16384
  s_add_u32 s42, s56, 8192
  buffer_load_dwordx4 v240, s[28:31], s56 offen lds
  s_add_u32 m0, s50, 17408
  s_nop 0
  buffer_load_dwordx4 v240, s[28:31], s42 offen lds
  s_add_u32 s56, s56, 16384
  s_cmp_eq_u32 s56, s59
  s_cselect_b32 s56, s58, s56
  s_add_u32 m0, s50, 18432
  s_add_u32 s42, s56, 8192
  buffer_load_dwordx4 v240, s[28:31], s56 offen lds
  s_add_u32 m0, s50, 19456
  s_nop 0
  buffer_load_dwordx4 v240, s[28:31], s42 offen lds
  s_add_u32 s56, s56, 16384
  s_cmp_eq_u32 s56, s59
  s_cselect_b32 s56, s58, s56
  s_waitcnt vmcnt(20)
  s_branch L_W23_35
L_W01_36:
  s_waitcnt vmcnt(0)
L_W23_35:
  s_cmp_eq_u32 s33, 15
  s_cbranch_scc1 L_NOF2_34
  s_mov_b64 exec, 1
  v_mov_b32 v250, s63
  v_mov_b32 v251, 0
  buffer_store_dword v250, v251, s[16:19], s44 offen sc1
  s_mov_b64 exec, -1
L_NOF2_34:
  v_lshrrev_b32 v2, 4, v1
  v_and_b32 v3, 1, v2
  v_lshrrev_b32 v2, 1, v2
  v_lshrrev_b32 v4, 2, v1
  v_and_b32 v4, 3, v4
  v_lshlrev_b32 v2, 2, v2
  v_add_u32 v2, v2, v4
  v_lshrrev_b32 v5, 1, v2
  v_and_b32 v5, 1, v5
  v_lshlrev_b32 v5, 1, v5
  v_lshlrev_b32 v2, 7, v2
  v_and_b32 v4, 3, v1
  v_lshlrev_b32 v4, 3, v4
  v_add_u32 v2, v2, v4
  v_add_u32 v2, s50, v2
  v_add_u32 v6, 0, v3
  v_xor_b32 v6, v6, v5
  v_lshlrev_b32 v6, 5, v6
  v_add_u32 v241, v2, v6
  v_add_u32 v6, 2, v3
  v_xor_b32 v6, v6, v5
  v_lshlrev_b32 v6, 5, v6
  v_add_u32 v242, v2, v6
  v_lshlrev_b32 v243, 4, v1
  s_mul_i32 s52, s37, 172
  s_lshl_b32 s52, s52, 10
  s_add_u32 s52, s52, 2097152
  v_add_u32 v244, 88064, v243
  s_lshl_b32 s61, s49, 10
  s_add_u32 s61, s61, s52
  s_lshl_b32 s62, s53, 10
  s_add_u32 s62, s62, s61
  s_lshl_b32 s60, s54, 10
  s_add_u32 s60, s60, s61
  s_cmp_lt_u32 s48, 2
  s_cbranch_scc1 L_Q01_37
  s_waitcnt vmcnt(0)
  s_branch L_QJ_38
L_Q01_37:
  s_add_u32 s56, s56, 16384
  s_cmp_eq_u32 s56, s59
  s_cselect_b32 s56, s58, s56
  s_add_u32 s56, s56, 16384
  s_cmp_eq_u32 s56, s59
  s_cselect_b32 s56, s58, s56
  s_add_u32 s56, s56, 16384
  s_cmp_eq_u32 s56, s59
  s_cselect_b32 s56, s58, s56
  s_add_u32 s56, s56, 16384
  s_cmp_eq_u32 s56, s59
  s_cselect_b32 s56, s58, s56
  s_add_u32 s56, s56, 16384
  s_cmp_eq_u32 s56, s59
  s_cselect_b32 s56, s58, s56
  s_add_u32 s56, s56, 16384
  s_cmp_eq_u32 s56, s59
  s_cselect_b32 s56, s58, s56
  s_add_u32 s56, s56, 16384
  s_cmp_eq_u32 s56, s59
  s_cselect_b32 s56, s58, s56
  s_add_u32 s56, s56, 16384
  s_cmp_eq_u32 s56, s59
  s_cselect_b32 s56, s58, s56
  s_add_u32 s56, s56, 16384
  s_cmp_eq_u32 s56, s59
  s_cselect_b32 s56, s58, s56
  s_add_u32 s56, s56, 16384
  s_cmp_eq_u32 s56, s59
  s_cselect_b32 s56, s58, s56
  v_mov_b32 v2, 160944
  s_mov_b32 s57, 0
L_LW_39:
  ds_read_b64 v[4:5], v2
  s_waitcnt lgkmcnt(0)
  v_and_b32 v4, v4, v5
  s_add_u32 s57, s57, 1
  v_readfirstlane_b32 s40, v4
  s_cmp_gt_u32 s57, 1000000
  s_cbranch_scc1 L_LWD_40
  s_cmp_eq_u32 s40, 0
  s_cbranch_scc0 L_LWD_40
  s_sleep 1
  s_branch L_LW_39
L_LWD_40:
L_QJ_38:
  ds_read_b64_tr_b16 v[8:9], v241 offset:0
  ds_read_b64_tr_b16 v[10:11], v241 offset:1024
  ds_read_b64_tr_b16 v[12:13], v242 offset:0
  ds_read_b64_tr_b16 v[14:15], v242 offset:1024
  ds_read_b64_tr_b16 v[16:17], v241 offset:2048
  ds_read_b64_tr_b16 v[18:19], v241 offset:3072
  ds_read_b64_tr_b16 v[20:21], v242 offset:2048
  ds_read_b64_tr_b16 v[22:23], v242 offset:3072
  ds_read_b64_tr_b16 v[24:25], v241 offset:4096
  ds_read_b64_tr_b16 v[26:27], v241 offset:5120
  ds_read_b64_tr_b16 v[28:29], v242 offset:4096
  ds_read_b64_tr_b16 v[30:31], v242 offset:5120
  ds_read_b64_tr_b16 v[32:33], v241 offset:6144
  ds_read_b64_tr_b16 v[34:35], v241 offset:7168
  ds_read_b64_tr_b16 v[36:37], v242 offset:6144
  ds_read_b64_tr_b16 v[38:39], v242 offset:7168
  ds_read_b64_tr_b16 v[40:41], v241 offset:8192
  ds_read_b64_tr_b16 v[42:43], v241 offset:9216
  ds_read_b64_tr_b16 v[44:45], v242 offset:8192
  ds_read_b64_tr_b16 v[46:47], v242 offset:9216
  ds_read_b64_tr_b16 v[48:49], v241 offset:10240
  ds_read_b64_tr_b16 v[50:51], v241 offset:11264
  ds_read_b64_tr_b16 v[52:53], v242 offset:10240
  ds_read_b64_tr_b16 v[54:55], v242 offset:11264
  ds_read_b64_tr_b16 v[56:57], v241 offset:12288
  ds_read_b64_tr_b16 v[58:59], v241 offset:13312
  ds_read_b64_tr_b16 v[60:61], v242 offset:12288
  ds_read_b64_tr_b16 v[62:63], v242 offset:13312
  ds_read_b64_tr_b16 v[64:65], v241 offset:14336
  ds_read_b64_tr_b16 v[66:67], v241 offset:15360
  ds_read_b64_tr_b16 v[68:69], v242 offset:14336
  ds_read_b64_tr_b16 v[70:71], v242 offset:15360
  ds_read_b64_tr_b16 v[72:73], v241 offset:16384
  ds_read_b64_tr_b16 v[74:75], v241 offset:17408
  ds_read_b64_tr_b16 v[76:77], v242 offset:16384
  ds_read_b64_tr_b16 v[78:79], v242 offset:17408
  ds_read_b64_tr_b16 v[80:81], v241 offset:18432
  ds_read_b64_tr_b16 v[82:83], v241 offset:19456
  ds_read_b64_tr_b16 v[84:85], v242 offset:18432
  ds_read_b64_tr_b16 v[86:87], v242 offset:19456
  s_waitcnt lgkmcnt(0)
  s_add_u32 m0, s50, 0
  s_add_u32 s42, s56, 8192
  buffer_load_dwordx4 v240, s[28:31], s56 offen lds
  s_add_u32 m0, s50, 1024
  s_nop 0
  buffer_load_dwordx4 v240, s[28:31], s42 offen lds
  s_add_u32 s56, s56, 16384
  s_cmp_eq_u32 s56, s59
  s_cselect_b32 s56, s58, s56
  s_add_u32 m0, s50, 2048
  s_add_u32 s42, s56, 8192
  buffer_load_dwordx4 v240, s[28:31], s56 offen lds
  s_add_u32 m0, s50, 3072
  s_nop 0
  buffer_load_dwordx4 v240, s[28:31], s42 offen lds
  s_add_u32 s56, s56, 16384
  s_cmp_eq_u32 s56, s59
  s_cselect_b32 s56, s58, s56
  s_add_u32 m0, s50, 4096
  s_add_u32 s42, s56, 8192
  buffer_load_dwordx4 v240, s[28:31], s56 offen lds
  s_add_u32 m0, s50, 5120
  s_nop 0
  buffer_load_dwordx4 v240, s[28:31], s42 offen lds
  s_add_u32 s56, s56, 16384
  s_cmp_eq_u32 s56, s59
  s_cselect_b32 s56, s58, s56
  s_add_u32 m0, s50, 6144
  s_add_u32 s42, s56, 8192
  buffer_load_dwordx4 v240, s[28:31], s56 offen lds
  s_add_u32 m0, s50, 7168
  s_nop 0
  buffer_load_dwordx4 v240, s[28:31], s42 offen lds
  s_add_u32 s56, s56, 16384
  s_cmp_eq_u32 s56, s59
  s_cselect_b32 s56, s58, s56
  s_add_u32 m0, s50, 8192
  s_add_u32 s42, s56, 8192
  buffer_load_dwordx4 v240, s[28:31], s56 offen lds
  s_add_u32 m0, s50, 9216
  s_nop 0
  buffer_load_dwordx4 v240, s[28:31], s42 offen lds
  s_add_u32 s56, s56, 16384
  s_cmp_eq_u32 s56, s59
  s_cselect_b32 s56, s58, s56
  s_add_u32 m0, s50, 10240
  s_add_u32 s42, s56, 8192
  buffer_load_dwordx4 v240, s[28:31], s56 offen lds
  s_add_u32 m0, s50, 11264
  s_nop 0
  buffer_load_dwordx4 v240, s[28:31], s42 offen lds
  s_add_u32 s56, s56, 16384
  s_cmp_eq_u32 s56, s59
  s_cselect_b32 s56, s58, s56
  s_add_u32 m0, s50, 12288
  s_add_u32 s42, s56, 8192
  buffer_load_dwordx4 v240, s[28:31], s56 offen lds
  s_add_u32 m0, s50, 13312
  s_nop 0
  buffer_load_dwordx4 v240, s[28:31], s42 offen lds
  s_add_u32 s56, s56, 16384
  s_cmp_eq_u32 s56, s59
  s_cselect_b32 s56, s58, s56
  s_add_u32 m0, s50, 14336
  s_add_u32 s42, s56, 8192
  buffer_load_dwordx4 v240, s[28:31], s56 offen lds
  s_add_u32 m0, s50, 15360
  s_nop 0
  buffer_load_dwordx4 v240, s[28:31], s42 offen lds
  s_add_u32 s56, s56, 16384
  s_cmp_eq_u32 s56, s59
  s_cselect_b32 s56, s58, s56
  s_add_u32 m0, s50, 16384
  s_add_u32 s42, s56, 8192
  buffer_load_dwordx4 v240, s[28:31], s56 offen lds
  s_add_u32 m0, s50, 17408
  s_nop 0
  buffer_load_dwordx4 v240, s[28:31], s42 offen lds
  s_add_u32 s56, s56, 16384
  s_cmp_eq_u32 s56, s59
  s_cselect_b32 s56, s58, s56
  s_add_u32 m0, s50, 18432
  s_add_u32 s42, s56, 8192
  buffer_load_dwordx4 v240, s[28:31], s56 offen lds
  s_add_u32 m0, s50, 19456
  s_nop 0
  buffer_load_dwordx4 v240, s[28:31], s42 offen lds
  s_add_u32 s56, s56, 16384
  s_cmp_eq_u32 s56, s59
  s_cselect_b32 s56, s58, s56
  v_lshrrev_b32 v2, 3, v0
  v_and_b32 v3, 7, v0
  v_lshlrev_b32 v245, 10, v2
  v_lshlrev_b32 v5, 4, v3
  v_add_u32 v245, v245, v5
  s_lshl_b32 s47, s37, 16
  s_lshl_b32 s46, s38, 7
  s_add_u32 s47, s47, s46
  buffer_load_dwordx4 v[246:249], v245, s[4:7], s47 offen
  s_mul_i32 s42, s49, 43
  s_lshr_b32 s42, s42, 8
  s_lshr_b32 s44, s37, 1
  s_lshl_b32 s44, s44, 8
  s_lshl_b32 s43, s42, 4
  s_add_u32 s44, s44, s43
  s_add_u32 s44, s44, 12689408
  s_sub_u32 s43, 15, s42
  s_min_u32 s43, s43, 5
  s_lshl_b32 s43, s43, 2
  s_sub_u32 s43, s43, 1
  v_min_u32 v3, s43, v1
  v_lshlrev_b32 v3, 2, v3
  s_mov_b32 s57, 0
L_PF_41:
  buffer_load_dword v2, v3, s[16:19], s44 offen sc1
  s_waitcnt vmcnt(0)
  v_cmp_ne_u32 vcc, s63, v2
  s_add_u32 s57, s57, 1
  s_cmp_eq_u64 vcc, 0
  s_cbranch_scc1 L_PFD_42
  s_cmp_gt_u32 s57, 100000
  s_cbranch_scc1 L_PFD_42
  s_sleep 16
  s_branch L_PF_41
L_PFD_42:
  buffer_load_dwordx4 v[96:99], v243, s[16:19], s60 offen sc1
  buffer_load_dwordx4 v[100:103], v244, s[16:19], s60 offen sc1
  s_add_u32 s60, s60, 1024
  s_cmp_eq_u32 s60, s62
  s_cselect_b32 s60, s61, s60
  buffer_load_dwordx4 v[104:107], v243, s[16:19], s60 offen sc1
  buffer_load_dwordx4 v[108:111], v244, s[16:19], s60 offen sc1
  s_add_u32 s60, s60, 1024
  s_cmp_eq_u32 s60, s62
  s_cselect_b32 s60, s61, s60
  buffer_load_dwordx4 v[112:115], v243, s[16:19], s60 offen sc1
  buffer_load_dwordx4 v[116:119], v244, s[16:19], s60 offen sc1
  s_add_u32 s60, s60, 1024
  s_cmp_eq_u32 s60, s62
  s_cselect_b32 s60, s61, s60
  buffer_load_dwordx4 v[120:123], v243, s[16:19], s60 offen sc1
  buffer_load_dwordx4 v[124:127], v244, s[16:19], s60 offen sc1
  s_add_u32 s60, s60, 1024
  s_cmp_eq_u32 s60, s62
  s_cselect_b32 s60, s61, s60
  buffer_load_dwordx4 v[128:131], v243, s[16:19], s60 offen sc1
  buffer_load_dwordx4 v[132:135], v244, s[16:19], s60 offen sc1
  s_add_u32 s60, s60, 1024
  s_cmp_eq_u32 s60, s62
  s_cselect_b32 s60, s61, s60
  buffer_load_dwordx4 v[136:139], v243, s[16:19], s60 offen sc1
  buffer_load_dwordx4 v[140:143], v244, s[16:19], s60 offen sc1
  s_add_u32 s60, s60, 1024
  s_cmp_eq_u32 s60, s62
  s_cselect_b32 s60, s61, s60
  buffer_load_dwordx4 v[144:147], v243, s[16:19], s60 offen sc1
  buffer_load_dwordx4 v[148:151], v244, s[16:19], s60 offen sc1
  s_add_u32 s60, s60, 1024
  s_cmp_eq_u32 s60, s62
  s_cselect_b32 s60, s61, s60
  buffer_load_dwordx4 v[152:155], v243, s[16:19], s60 offen sc1
  buffer_load_dwordx4 v[156:159], v244, s[16:19], s60 offen sc1
  s_add_u32 s60, s60, 1024
  s_cmp_eq_u32 s60, s62
  s_cselect_b32 s60, s61, s60
  buffer_load_dwordx4 v[160:163], v243, s[16:19], s60 offen sc1
  buffer_load_dwordx4 v[164:167], v244, s[16:19], s60 offen sc1
  s_add_u32 s60, s60, 1024
  s_cmp_eq_u32 s60, s62
  s_cselect_b32 s60, s61, s60
  buffer_load_dwordx4 v[168:171], v243, s[16:19], s60 offen sc1
  buffer_load_dwordx4 v[172:175], v244, s[16:19], s60 offen sc1
  s_add_u32 s60, s60, 1024
  s_cmp_eq_u32 s60, s62
  s_cselect_b32 s60, s61, s60
  buffer_load_dwordx4 v[88:91], v243, s[16:19], s60 offen sc1
  buffer_load_dwordx4 v[92:95], v244, s[16:19], s60 offen sc1
  s_add_u32 s60, s60, 1024
  s_cmp_eq_u32 s60, s62
  s_cselect_b32 s60, s61, s60
  s_waitcnt vmcnt(20)
  v_mfma_f32_32x32x16_bf16 v[176:191], v[8:11], v[96:99], 0
  v_mfma_f32_32x32x16_bf16 v[192:207], v[8:11], v[100:103], 0
  v_mfma_f32_32x32x16_bf16 v[208:223], v[12:15], v[96:99], 0
  v_mfma_f32_32x32x16_bf16 v[224:239], v[12:15], v[100:103], 0
  s_waitcnt vmcnt(18)
  v_mfma_f32_32x32x16_bf16 v[176:191], v[16:19], v[104:107], v[176:191]
  buffer_load_dwordx4 v[96:99], v243, s[16:19], s60 offen sc1
  v_mfma_f32_32x32x16_bf16 v[192:207], v[16:19], v[108:111], v[192:207]
  buffer_load_dwordx4 v[100:103], v244, s[16:19], s60 offen sc1
  v_mfma_f32_32x32x16_bf16 v[208:223], v[20:23], v[104:107], v[208:223]
  s_add_u32 s60, s60, 1024
  v_mfma_f32_32x32x16_bf16 v[224:239], v[20:23], v[108:111], v[224:239]
  s_cmp_eq_u32 s60, s62
  s_cselect_b32 s60, s61, s60
  s_waitcnt vmcnt(18)
  v_mfma_f32_32x32x16_bf16 v[176:191], v[24:27], v[112:115], v[176:191]
  buffer_load_dwordx4 v[104:107], v243, s[16:19], s60 offen sc1
  v_mfma_f32_32x32x16_bf16 v[192:207], v[24:27], v[116:119], v[192:207]
  buffer_load_dwordx4 v[108:111], v244, s[16:19], s60 offen sc1
  v_mfma_f32_32x32x16_bf16 v[208:223], v[28:31], v[112:115], v[208:223]
  s_add_u32 s60, s60, 1024
  v_mfma_f32_32x32x16_bf16 v[224:239], v[28:31], v[116:119], v[224:239]
  s_cmp_eq_u32 s60, s62
  s_cselect_b32 s60, s61, s60
  s_waitcnt vmcnt(18)
  v_mfma_f32_32x32x16_bf16 v[176:191], v[32:35], v[120:123], v[176:191]
  buffer_load_dwordx4 v[112:115], v243, s[16:19], s60 offen sc1
  v_mfma_f32_32x32x16_bf16 v[192:207], v[32:35], v[124:127], v[192:207]
  buffer_load_dwordx4 v[116:119], v244, s[16:19], s60 offen sc1
  v_mfma_f32_32x32x16_bf16 v[208:223], v[36:39], v[120:123], v[208:223]
  s_add_u32 s60, s60, 1024
  v_mfma_f32_32x32x16_bf16 v[224:239], v[36:39], v[124:127], v[224:239]
  s_cmp_eq_u32 s60, s62
  s_cselect_b32 s60, s61, s60
  s_waitcnt vmcnt(18)
  v_mfma_f32_32x32x16_bf16 v[176:191], v[40:43], v[128:131], v[176:191]
  buffer_load_dwordx4 v[120:123], v243, s[16:19], s60 offen sc1
  v_mfma_f32_32x32x16_bf16 v[192:207], v[40:43], v[132:135], v[192:207]
  buffer_load_dwordx4 v[124:127], v244, s[16:19], s60 offen sc1
  v_mfma_f32_32x32x16_bf16 v[208:223], v[44:47], v[128:131], v[208:223]
  s_add_u32 s60, s60, 1024
  v_mfma_f32_32x32x16_bf16 v[224:239], v[44:47], v[132:135], v[224:239]
  s_cmp_eq_u32 s60, s62
  s_cselect_b32 s60, s61, s60
  s_waitcnt vmcnt(18)
  v_mfma_f32_32x32x16_bf16 v[176:191], v[48:51], v[136:139], v[176:191]
  buffer_load_dwordx4 v[128:131], v243, s[16:19], s60 offen sc1
  v_mfma_f32_32x32x16_bf16 v[192:207], v[48:51], v[140:143], v[192:207]
  buffer_load_dwordx4 v[132:135], v244, s[16:19], s60 offen sc1
  v_mfma_f32_32x32x16_bf16 v[208:223], v[52:55], v[136:139], v[208:223]
  s_add_u32 s60, s60, 1024
  v_mfma_f32_32x32x16_bf16 v[224:239], v[52:55], v[140:143], v[224:239]
  s_cmp_eq_u32 s60, s62
  s_cselect_b32 s60, s61, s60
  s_waitcnt vmcnt(18)
  v_mfma_f32_32x32x16_bf16 v[176:191], v[56:59], v[144:147], v[176:191]
  buffer_load_dwordx4 v[136:139], v243, s[16:19], s60 offen sc1
  v_mfma_f32_32x32x16_bf16 v[192:207], v[56:59], v[148:151], v[192:207]
  buffer_load_dwordx4 v[140:143], v244, s[16:19], s60 offen sc1
  v_mfma_f32_32x32x16_bf16 v[208:223], v[60:63], v[144:147], v[208:223]
  s_add_u32 s60, s60, 1024
  v_mfma_f32_32x32x16_bf16 v[224:239], v[60:63], v[148:151], v[224:239]
  s_cmp_eq_u32 s60, s62
  s_cselect_b32 s60, s61, s60
  s_waitcnt vmcnt(18)
  v_mfma_f32_32x32x16_bf16 v[176:191], v[64:67], v[152:155], v[176:191]
  buffer_load_dwordx4 v[144:147], v243, s[16:19], s60 offen sc1
  v_mfma_f32_32x32x16_bf16 v[192:207], v[64:67], v[156:159], v[192:207]
  buffer_load_dwordx4 v[148:151], v244, s[16:19], s60 offen sc1
  v_mfma_f32_32x32x16_bf16 v[208:223], v[68:71], v[152:155], v[208:223]
  s_add_u32 s60, s60, 1024
  v_mfma_f32_32x32x16_bf16 v[224:239], v[68:71], v[156:159], v[224:239]
  s_cmp_eq_u32 s60, s62
  s_cselect_b32 s60, s61, s60
  s_waitcnt vmcnt(18)
  v_mfma_f32_32x32x16_bf16 v[176:191], v[72:75], v[160:163], v[176:191]
  buffer_load_dwordx4 v[152:155], v243, s[16:19], s60 offen sc1
  v_mfma_f32_32x32x16_bf16 v[192:207], v[72:75], v[164:167], v[192:207]
  buffer_load_dwordx4 v[156:159], v244, s[16:19], s60 offen sc1
  v_mfma_f32_32x32x16_bf16 v[208:223], v[76:79], v[160:163], v[208:223]
  s_add_u32 s60, s60, 1024
  v_mfma_f32_32x32x16_bf16 v[224:239], v[76:79], v[164:167], v[224:239]
  s_cmp_eq_u32 s60, s62
  s_cselect_b32 s60, s61, s60
  s_waitcnt vmcnt(18)
  v_mfma_f32_32x32x16_bf16 v[176:191], v[80:83], v[168:171], v[176:191]
  ds_read_b64_tr_b16 v[8:9], v241 offset:0
  ds_read_b64_tr_b16 v[10:11], v241 offset:1024
  v_mfma_f32_32x32x16_bf16 v[192:207], v[80:83], v[172:175], v[192:207]
  ds_read_b64_tr_b16 v[12:13], v242 offset:0
  ds_read_b64_tr_b16 v[14:15], v242 offset:1024
  v_mfma_f32_32x32x16_bf16 v[208:223], v[84:87], v[168:171], v[208:223]
  buffer_load_dwordx4 v[160:163], v243, s[16:19], s60 offen sc1
  v_mfma_f32_32x32x16_bf16 v[224:239], v[84:87], v[172:175], v[224:239]
  buffer_load_dwordx4 v[164:167], v244, s[16:19], s60 offen sc1
  s_add_u32 s60, s60, 1024
  s_cmp_eq_u32 s60, s62
  s_cselect_b32 s60, s61, s60
  s_waitcnt vmcnt(18) lgkmcnt(0)
  v_mfma_f32_32x32x16_bf16 v[176:191], v[8:11], v[88:91], v[176:191]
  ds_read_b64_tr_b16 v[16:17], v241 offset:2048
  ds_read_b64_tr_b16 v[18:19], v241 offset:3072
  v_mfma_f32_32x32x16_bf16 v[192:207], v[8:11], v[92:95], v[192:207]
  ds_read_b64_tr_b16 v[20:21], v242 offset:2048
  ds_read_b64_tr_b16 v[22:23], v242 offset:3072
  v_mfma_f32_32x32x16_bf16 v[208:223], v[12:15], v[88:91], v[208:223]
  buffer_load_dwordx4 v[168:171], v243, s[16:19], s60 offen sc1
  v_mfma_f32_32x32x16_bf16 v[224:239], v[12:15], v[92:95], v[224:239]
  buffer_load_dwordx4 v[172:175], v244, s[16:19], s60 offen sc1
  s_add_u32 s60, s60, 1024
  s_cmp_eq_u32 s60, s62
  s_cselect_b32 s60, s61, s60
  s_add_u32 m0, s50, 0
  s_add_u32 s42, s56, 8192
  buffer_load_dwordx4 v240, s[28:31], s56 offen lds
  s_add_u32 m0, s50, 1024
  s_nop 0
  buffer_load_dwordx4 v240, s[28:31], s42 offen lds
  s_add_u32 s56, s56, 16384
  s_cmp_eq_u32 s56, s59
  s_cselect_b32 s56, s58, s56
  s_waitcnt vmcnt(20) lgkmcnt(0)
  v_mfma_f32_32x32x16_bf16 v[176:191], v[16:19], v[96:99], v[176:191]
  ds_read_b64_tr_b16 v[24:25], v241 offset:4096
  ds_read_b64_tr_b16 v[26:27], v241 offset:5120
  v_mfma_f32_32x32x16_bf16 v[192:207], v[16:19], v[100:103], v[192:207]
  ds_read_b64_tr_b16 v[28:29], v242 offset:4096
  ds_read_b64_tr_b16 v[30:31], v242 offset:5120
  v_mfma_f32_32x32x16_bf16 v[208:223], v[20:23], v[96:99], v[208:223]
  buffer_load_dwordx4 v[88:91], v243, s[16:19], s60 offen sc1
  v_mfma_f32_32x32x16_bf16 v[224:239], v[20:23], v[100:103], v[224:239]
  buffer_load_dwordx4 v[92:95], v244, s[16:19], s60 offen sc1
  s_add_u32 s60, s60, 1024
  s_cmp_eq_u32 s60, s62
  s_cselect_b32 s60, s61, s60
  s_add_u32 m0, s50, 2048
  s_add_u32 s42, s56, 8192
  buffer_load_dwordx4 v240, s[28:31], s56 offen lds
  s_add_u32 m0, s50, 3072
  s_nop 0
  buffer_load_dwordx4 v240, s[28:31], s42 offen lds
  s_add_u32 s56, s56, 16384
  s_cmp_eq_u32 s56, s59
  s_cselect_b32 s56, s58, s56
  s_waitcnt vmcnt(22) lgkmcnt(0)
  v_mfma_f32_32x32x16_bf16 v[176:191], v[24:27], v[104:107], v[176:191]
  ds_read_b64_tr_b16 v[32:33], v241 offset:6144
  ds_read_b64_tr_b16 v[34:35], v241 offset:7168
  v_mfma_f32_32x32x16_bf16 v[192:207], v[24:27], v[108:111], v[192:207]
  ds_read_b64_tr_b16 v[36:37], v242 offset:6144
  ds_read_b64_tr_b16 v[38:39], v242 offset:7168
  v_mfma_f32_32x32x16_bf16 v[208:223], v[28:31], v[104:107], v[208:223]
  v_mfma_f32_32x32x16_bf16 v[224:239], v[28:31], v[108:111], v[224:239]
  s_waitcnt vmcnt(20) lgkmcnt(0)
  v_mfma_f32_32x32x16_bf16 v[176:191], v[32:35], v[112:115], v[176:191]
  ds_read_b64_tr_b16 v[40:41], v241 offset:8192
  ds_read_b64_tr_b16 v[42:43], v241 offset:9216
  v_mfma_f32_32x32x16_bf16 v[192:207], v[32:35], v[116:119], v[192:207]
  ds_read_b64_tr_b16 v[44:45], v242 offset:8192
  ds_read_b64_tr_b16 v[46:47], v242 offset:9216
  v_mfma_f32_32x32x16_bf16 v[208:223], v[36:39], v[112:115], v[208:223]
  v_mfma_f32_32x32x16_bf16 v[224:239], v[36:39], v[116:119], v[224:239]
  s_waitcnt vmcnt(18) lgkmcnt(0)
  v_mfma_f32_32x32x16_bf16 v[176:191], v[40:43], v[120:123], v[176:191]
  ds_read_b64_tr_b16 v[48:49], v241 offset:10240
  ds_read_b64_tr_b16 v[50:51], v241 offset:11264
  v_mfma_f32_32x32x16_bf16 v[192:207], v[40:43], v[124:127], v[192:207]
  ds_read_b64_tr_b16 v[52:53], v242 offset:10240
  ds_read_b64_tr_b16 v[54:55], v242 offset:11264
  v_mfma_f32_32x32x16_bf16 v[208:223], v[44:47], v[120:123], v[208:223]
  v_mfma_f32_32x32x16_bf16 v[224:239], v[44:47], v[124:127], v[224:239]
  s_waitcnt vmcnt(16) lgkmcnt(0)
  v_mfma_f32_32x32x16_bf16 v[176:191], v[48:51], v[128:131], v[176:191]
  ds_read_b64_tr_b16 v[56:57], v241 offset:12288
  ds_read_b64_tr_b16 v[58:59], v241 offset:13312
  v_mfma_f32_32x32x16_bf16 v[192:207], v[48:51], v[132:135], v[192:207]
  ds_read_b64_tr_b16 v[60:61], v242 offset:12288
  ds_read_b64_tr_b16 v[62:63], v242 offset:13312
  v_mfma_f32_32x32x16_bf16 v[208:223], v[52:55], v[128:131], v[208:223]
  v_mfma_f32_32x32x16_bf16 v[224:239], v[52:55], v[132:135], v[224:239]
  s_waitcnt vmcnt(14) lgkmcnt(0)
  v_mfma_f32_32x32x16_bf16 v[176:191], v[56:59], v[136:139], v[176:191]
  ds_read_b64_tr_b16 v[64:65], v241 offset:14336
  ds_read_b64_tr_b16 v[66:67], v241 offset:15360
  v_mfma_f32_32x32x16_bf16 v[192:207], v[56:59], v[140:143], v[192:207]
  ds_read_b64_tr_b16 v[68:69], v242 offset:14336
  ds_read_b64_tr_b16 v[70:71], v242 offset:15360
  v_mfma_f32_32x32x16_bf16 v[208:223], v[60:63], v[136:139], v[208:223]
  v_mfma_f32_32x32x16_bf16 v[224:239], v[60:63], v[140:143], v[224:239]
  s_waitcnt vmcnt(12) lgkmcnt(0)
  v_mfma_f32_32x32x16_bf16 v[176:191], v[64:67], v[144:147], v[176:191]
  ds_read_b64_tr_b16 v[72:73], v241 offset:16384
  ds_read_b64_tr_b16 v[74:75], v241 offset:17408
  v_mfma_f32_32x32x16_bf16 v[192:207], v[64:67], v[148:151], v[192:207]
  ds_read_b64_tr_b16 v[76:77], v242 offset:16384
  ds_read_b64_tr_b16 v[78:79], v242 offset:17408
  v_mfma_f32_32x32x16_bf16 v[208:223], v[68:71], v[144:147], v[208:223]
  v_mfma_f32_32x32x16_bf16 v[224:239], v[68:71], v[148:151], v[224:239]
  s_waitcnt vmcnt(10) lgkmcnt(0)
  v_mfma_f32_32x32x16_bf16 v[176:191], v[72:75], v[152:155], v[176:191]
  ds_read_b64_tr_b16 v[80:81], v241 offset:18432
  ds_read_b64_tr_b16 v[82:83], v241 offset:19456
  v_mfma_f32_32x32x16_bf16 v[192:207], v[72:75], v[156:159], v[192:207]
  ds_read_b64_tr_b16 v[84:85], v242 offset:18432
  ds_read_b64_tr_b16 v[86:87], v242 offset:19456
  v_mfma_f32_32x32x16_bf16 v[208:223], v[76:79], v[152:155], v[208:223]
  v_mfma_f32_32x32x16_bf16 v[224:239], v[76:79], v[156:159], v[224:239]
  s_waitcnt vmcnt(4) lgkmcnt(0)
  v_mfma_f32_32x32x16_bf16 v[176:191], v[80:83], v[160:163], v[176:191]
  ds_read_b64_tr_b16 v[8:9], v241 offset:0
  ds_read_b64_tr_b16 v[10:11], v241 offset:1024
  v_mfma_f32_32x32x16_bf16 v[192:207], v[80:83], v[164:167], v[192:207]
  ds_read_b64_tr_b16 v[12:13], v242 offset:0
  ds_read_b64_tr_b16 v[14:15], v242 offset:1024
  v_mfma_f32_32x32x16_bf16 v[208:223], v[84:87], v[160:163], v[208:223]
  v_mfma_f32_32x32x16_bf16 v[224:239], v[84:87], v[164:167], v[224:239]
  s_waitcnt vmcnt(0) lgkmcnt(0)
  v_mfma_f32_32x32x16_bf16 v[176:191], v[8:11], v[168:171], v[176:191]
  ds_read_b64_tr_b16 v[16:17], v241 offset:2048
  ds_read_b64_tr_b16 v[18:19], v241 offset:3072
  v_mfma_f32_32x32x16_bf16 v[192:207], v[8:11], v[172:175], v[192:207]
  ds_read_b64_tr_b16 v[20:21], v242 offset:2048
  ds_read_b64_tr_b16 v[22:23], v242 offset:3072
  v_mfma_f32_32x32x16_bf16 v[208:223], v[12:15], v[168:171], v[208:223]
  v_mfma_f32_32x32x16_bf16 v[224:239], v[12:15], v[172:175], v[224:239]
  s_waitcnt vmcnt(0) lgkmcnt(0)
  s_cmp_ge_u32 s48, 2
  s_cbranch_scc1 L_G2SKIP_43
  v_mfma_f32_32x32x16_bf16 v[176:191], v[16:19], v[88:91], v[176:191]
  v_mfma_f32_32x32x16_bf16 v[192:207], v[16:19], v[92:95], v[192:207]
  v_mfma_f32_32x32x16_bf16 v[208:223], v[20:23], v[88:91], v[208:223]
  v_mfma_f32_32x32x16_bf16 v[224:239], v[20:23], v[92:95], v[224:239]
L_G2SKIP_43:
  s_nop 7
  s_nop 7
  v_and_b32 v2, 31, v1
  v_mul_u32_u24 v2, 272, v2
  v_lshrrev_b32 v3, 5, v1
  v_lshlrev_b32 v3, 4, v3
  v_add_u32 v2, v2, v3
  v_add_u32 v2, s50, v2
  ds_write_b128 v2, v[176:179] offset:0
  ds_write_b128 v2, v[180:183] offset:32
  ds_write_b128 v2, v[184:187] offset:64
  ds_write_b128 v2, v[188:191] offset:96
  ds_write_b128 v2, v[192:195] offset:8704
  ds_write_b128 v2, v[196:199] offset:8736
  ds_write_b128 v2, v[200:203] offset:8768
  ds_write_b128 v2, v[204:207] offset:8800
  ds_write_b128 v2, v[208:211] offset:128
  ds_write_b128 v2, v[212:215] offset:160
  ds_write_b128 v2, v[216:219] offset:192
  ds_write_b128 v2, v[220:223] offset:224
  ds_write_b128 v2, v[224:227] offset:8832
  ds_write_b128 v2, v[228:231] offset:8864
  ds_write_b128 v2, v[232:235] offset:8896
  ds_write_b128 v2, v[236:239] offset:8928
  s_waitcnt lgkmcnt(0)
L_P_F:
  s_barrier
  v_lshrrev_b32 v2, 3, v0
  v_and_b32 v3, 7, v0
  v_mul_u32_u24 v4, 272, v2
  v_lshlrev_b32 v5, 5, v3
  v_add_u32 v4, v4, v5
  ds_read_b128 v[8:11], v4 offset:0
  ds_read_b128 v[12:15], v4 offset:16
  ds_read_b128 v[24:27], v4 offset:20480
  ds_read_b128 v[28:31], v4 offset:20496
  v_add_u32 v4, 107264, v4
  ds_read_b128 v[16:19], v4 offset:0
  ds_read_b128 v[20:23], v4 offset:16
  ds_read_b128 v[32:35], v4 offset:20480
  ds_read_b128 v[36:39], v4 offset:20496
  v_lshlrev_b32 v6, 2, v2
  v_add_u32 v6, 161024, v6
  ds_read_b32 v239, v6
  v_mul_u32_u24 v6, 1056, v3
  v_lshlrev_b32 v7, 1, v2
  v_add_u32 v6, v6, v7
  v_add_u32 v6, 98816, v6
  ds_read_u16 v48, v6 offset:0
  ds_read_u16 v49, v6 offset:132
  ds_read_u16 v50, v6 offset:264
  ds_read_u16 v51, v6 offset:396
  ds_read_u16 v52, v6 offset:528
  ds_read_u16 v53, v6 offset:660
  ds_read_u16 v54, v6 offset:792
  ds_read_u16 v55, v6 offset:924
  s_lshl_b32 s42, s37, 16
  s_lshl_b32 s43, s38, 7
  s_add_u32 s42, s42, s43
  s_waitcnt lgkmcnt(0)
  v_add_f32 v8, v8, v24
  v_add_f32 v16, v16, v32
  v_add_f32 v9, v9, v25
  v_add_f32 v17, v17, v33
  v_add_f32 v10, v10, v26
  v_add_f32 v18, v18, v34
  v_add_f32 v11, v11, v27
  v_add_f32 v19, v19, v35
  v_add_f32 v12, v12, v28
  v_add_f32 v20, v20, v36
  v_add_f32 v13, v13, v29
  v_add_f32 v21, v21, v37
  v_add_f32 v14, v14, v30
  v_add_f32 v22, v22, v38
  v_add_f32 v15, v15, v31
  v_add_f32 v23, v23, v39
  v_add_f32 v8, v8, v16
  v_add_f32 v9, v9, v17
  v_add_f32 v10, v10, v18
  v_add_f32 v11, v11, v19
  v_add_f32 v12, v12, v20
  v_add_f32 v13, v13, v21
  v_add_f32 v14, v14, v22
  v_add_f32 v15, v15, v23
  v_mul_f32 v8, v8, v239
  v_mul_f32 v9, v9, v239
  v_mul_f32 v10, v10, v239
  v_mul_f32 v11, v11, v239
  v_mul_f32 v12, v12, v239
  v_mul_f32 v13, v13, v239
  v_mul_f32 v14, v14, v239
  v_mul_f32 v15, v15, v239
  v_cvt_pk_bf16_f32 v16, v8, v9
  v_cvt_pk_bf16_f32 v17, v10, v11
  v_cvt_pk_bf16_f32 v18, v12, v13
  v_cvt_pk_bf16_f32 v19, v14, v15
  s_waitcnt vmcnt(0)
  v_lshlrev_b32 v24, 16, v246
  v_and_b32 v25, 0xffff0000, v246
  v_lshlrev_b32 v26, 16, v247
  v_and_b32 v27, 0xffff0000, v247
  v_lshlrev_b32 v28, 16, v248
  v_and_b32 v29, 0xffff0000, v248
  v_lshlrev_b32 v30, 16, v249
  v_and_b32 v31, 0xffff0000, v249
  v_lshlrev_b32 v48, 16, v48
  v_add_f32 v24, v24, v48
  v_lshlrev_b32 v49, 16, v49
  v_add_f32 v25, v25, v49
  v_lshlrev_b32 v50, 16, v50
  v_add_f32 v26, v26, v50
  v_lshlrev_b32 v51, 16, v51
  v_add_f32 v27, v27, v51
  v_lshlrev_b32 v52, 16, v52
  v_add_f32 v28, v28, v52
  v_lshlrev_b32 v53, 16, v53
  v_add_f32 v29, v29, v53
  v_lshlrev_b32 v54, 16, v54
  v_add_f32 v30, v30, v54
  v_lshlrev_b32 v55, 16, v55
  v_add_f32 v31, v31, v55
  v_cvt_pk_bf16_f32 v32, v24, v25
  v_cvt_pk_bf16_f32 v33, v26, v27
  v_cvt_pk_bf16_f32 v34, v28, v29
  v_cvt_pk_bf16_f32 v35, v30, v31
  v_lshlrev_b32 v24, 16, v32
  v_and_b32 v25, 0xffff0000, v32
  v_lshlrev_b32 v8, 16, v16
  v_and_b32 v9, 0xffff0000, v16
  v_lshlrev_b32 v26, 16, v33
  v_and_b32 v27, 0xffff0000, v33
  v_lshlrev_b32 v10, 16, v17
  v_and_b32 v11, 0xffff0000, v17
  v_lshlrev_b32 v28, 16, v34
  v_and_b32 v29, 0xffff0000, v34
  v_lshlrev_b32 v12, 16, v18
  v_and_b32 v13, 0xffff0000, v18
  v_lshlrev_b32 v30, 16, v35
  v_and_b32 v31, 0xffff0000, v35
  v_lshlrev_b32 v14, 16, v19
  v_and_b32 v15, 0xffff0000, v19
  v_add_f32 v24, v24, v8
  v_add_f32 v25, v25, v9
  v_add_f32 v26, v26, v10
  v_add_f32 v27, v27, v11
  v_add_f32 v28, v28, v12
  v_add_f32 v29, v29, v13
  v_add_f32 v30, v30, v14
  v_add_f32 v31, v31, v15
  v_cvt_pk_bf16_f32 v32, v24, v25
  v_cvt_pk_bf16_f32 v33, v26, v27
  v_cvt_pk_bf16_f32 v34, v28, v29
  v_cvt_pk_bf16_f32 v35, v30, v31
  buffer_store_dwordx4 v[32:35], v245, s[24:27], s42 offen sc1
  s_waitcnt vmcnt(0)
L_END:

s_endpgm
.section .rodata,"a"
.p2align 6
.amdhsa_kernel parallel_sum__ssm_conv_s4d__glu_gated_glu__prompt_kernel
  .amdhsa_next_free_vgpr 256
  .amdhsa_next_free_sgpr 102
  .amdhsa_accum_offset 256
  .amdhsa_group_segment_fixed_size 0
  .amdhsa_kernarg_size 112
  .amdhsa_user_sgpr_count 2
  .amdhsa_user_sgpr_kernarg_segment_ptr 1
  .amdhsa_system_sgpr_workgroup_id_x 1
.end_amdhsa_kernel
.text
```
